```python
import torch

def _softmax(x, axis=-1):
    return torch.softmax(x, dim=axis)
def _gelu(x):
    return torch.nn.functional.gelu(x, approximate="tanh")
def _silu(x):
    return torch.nn.functional.silu(x)
def _sigmoid(x):
    return torch.sigmoid(x)
def _layernorm(x, axis=-1, eps=1e-5):
    m = x.mean(dim=axis, keepdim=True)
    v = x.var(dim=axis, keepdim=True, unbiased=False)
    return (x - m) / torch.sqrt(v + eps)
def _scatter_add(tgt, idx, src, axis=0):
    return tgt.clone().index_add_(axis, idx, src)
def _segment_sum(src, seg, n):
    out = torch.zeros((n,) + src.shape[1:], dtype=src.dtype)
    return out.index_add_(0, seg, src)
def _pad(x, pw):
    flat = tuple(v for pair in reversed(pw) for v in pair)
    return torch.nn.functional.pad(x, flat)

kernel_name = 'parallel_sum__mha_block_cached__swiglu_ffn__decode'

def setup_inputs():

    _w = (lambda a: (lambda t: t.to(torch.bfloat16) if t.is_floating_point() else t)(torch.as_tensor(a)))
    def _A_setup():
        B, Sq, D = 4, 1, 640
        H, Sk, Dh = 32, 4096, 128
        return {
            "x": _w((lambda *s: torch.randn(*s, dtype=torch.bfloat16) * 0.05)(B, Sq, D)),
            "k_cache": _w((lambda *s: torch.randn(*s, dtype=torch.bfloat16) * 3.2)(B, H, Sk, Dh)),
            "v_cache": _w((lambda *s: torch.randn(*s, dtype=torch.bfloat16) * 1.6)(B, H, Sk, Dh)),
            "wq": _w((lambda *s: torch.randn(*s, dtype=torch.bfloat16) * 3.2)(D, H * Dh) * (D ** -0.5)),
            "wo": _w((lambda *s: torch.randn(*s, dtype=torch.bfloat16) * 1.6)(H * Dh, D) * ((H * Dh) ** -0.5)),
        }
    _A_in = _A_setup()

    def _B_setup():
        B, S, D, F = 4, 1, 640, 1728
        return {
            "x": _w((lambda *s: torch.randn(*s, dtype=torch.bfloat16) * 0.05)(B, S, D)),
            "w_gate": _w((lambda *s: torch.randn(*s, dtype=torch.bfloat16) * 0.05)(D, F)),
            "w_up": _w((lambda *s: torch.randn(*s, dtype=torch.bfloat16) * 0.05)(D, F)),
            "w_down": _w((lambda *s: torch.randn(*s, dtype=torch.bfloat16) * 0.05)(F, D)),
        }
    _B_in = _B_setup()

    return {
        "A_x": _A_in["x"],
        "A_k_cache": _A_in["k_cache"],
        "A_v_cache": _A_in["v_cache"],
        "A_wq": _A_in["wq"],
        "A_wo": _A_in["wo"],
        "B_x": _B_in["x"],
        "B_w_gate": _B_in["w_gate"],
        "B_w_up": _B_in["w_up"],
        "B_w_down": _B_in["w_down"],
    }

def reference(A_x, A_k_cache, A_v_cache, A_wq, A_wo, B_x, B_w_gate, B_w_up, B_w_down):
    def _A_ref(x, k_cache, v_cache, wq, wo):
        B, Sq, D = x.shape
        H, Dh = 32, 128
        q = (lambda x, *d: x.permute(*d))((x @ wq).reshape(B, Sq, H, Dh), 0, 2, 1, 3)
        scores = torch.einsum("bhqd,bhkd->bhqk", q, k_cache) * (Dh ** -0.5)
        p = _softmax(scores, axis=-1)
        o = torch.einsum("bhqk,bhkd->bhqd", p, v_cache)
        return (lambda x, *d: x.permute(*d))(o, 0, 2, 1, 3).reshape(B, Sq, H * Dh) @ wo

    def _B_ref(x, w_gate, w_up, w_down):
        g = _silu(x @ w_gate)
        u = x @ w_up
        return (g * u) @ w_down

    x = A_x
    xn = _layernorm(x, axis=-1)
    return x + _A_ref(xn, A_k_cache, A_v_cache, A_wq, A_wo) + _B_ref(xn, B_w_gate, B_w_up, B_w_down)
```

```asm
; @launch grid=(256,1,1) block=(512,1,1) lds=51520
.amdgcn_target "amdgcn-amd-amdhsa--gfx950"
.text
.globl parallel_sum__mha_block_cached__swiglu_ffn__decode_kernel
.p2align 8
.type parallel_sum__mha_block_cached__swiglu_ffn__decode_kernel,@function
parallel_sum__mha_block_cached__swiglu_ffn__decode_kernel:
    s_cmp_ge_u32 s2, 256
    s_cbranch_scc1 L_end
    s_load_dwordx16 s[16:31], s[0:1], 0
    s_load_dwordx8 s[32:39], s[0:1], 64
    v_lshrrev_b32 v1, 6, v0
    v_mov_b32 v8, 0
    v_readfirstlane_b32 s3, v1
    v_and_b32 v20, 63, v0
    s_and_b32 s4, s2, 31
    s_lshr_b32 s5, s2, 6
    s_bfe_u32 s6, s2, 0x10005
    s_and_b32 s7, s4, 7
    s_lshl_b32 s7, s7, 2
    s_lshr_b32 s9, s4, 3
    s_add_u32 s7, s7, s9
    s_mov_b32 s91, 0x3fb8aa3b
    s_and_b32 s15, s3, 3
    s_cmp_lt_u32 s3, 4
    s_cbranch_scc1 L_helper
    s_lshl_b32 s10, s5, 5
    s_add_u32 s10, s10, s4
    s_lshl_b32 s10, s10, 20
    s_mul_i32 s11, s6, 32768
    s_add_u32 s10, s10, s11
    s_lshl_b32 s11, s15, 12
    s_add_u32 s10, s10, s11
    v_lshl_add_u32 v1, v20, 4, s10
    s_mov_b32 s42, 0x8000000
    s_mov_b32 s43, 0x20000
    s_waitcnt lgkmcnt(0)
    s_mov_b64 s[40:41], s[18:19]
    buffer_load_dwordx4 v[64:67], v1, s[40:43], 0 offen offset:0 nt
    buffer_load_dwordx4 v[68:71], v1, s[40:43], 0 offen offset:1024 nt
    buffer_load_dwordx4 v[72:75], v1, s[40:43], 0 offen offset:2048 nt
    buffer_load_dwordx4 v[76:79], v1, s[40:43], 0 offen offset:3072 nt
    s_mov_b32 s8, 16384
    buffer_load_dwordx4 v[80:83], v1, s[40:43], s8 offen offset:0 nt
    s_mov_b64 s[44:45], s[20:21]
    s_mov_b32 s46, 0x8000000
    s_mov_b32 s47, 0x20000
    s_mov_b64 s[76:77], s[38:39]
    s_mov_b32 s78, 0x20000000
    s_mov_b32 s79, 0x20000
    s_mov_b64 s[68:69], s[34:35]
    s_mov_b32 s70, 0x1400
    s_mov_b32 s71, 0x20000
    s_mov_b64 s[56:57], s[16:17]
    s_mov_b32 s58, 0x1400
    s_mov_b32 s59, 0x20000
    s_mov_b32 s86, 0xcccccccc
    s_mov_b32 s87, 0xcccccccc
    s_mov_b32 s88, 0xaaaaaaaa
    s_mov_b32 s89, 0xaaaaaaaa
    v_and_b32 v21, 1, v0
    v_cmp_eq_u32 vcc, 1, v21
    v_mov_b32 v22, 0xffff
    v_mov_b32 v23, 0xffff0000
    v_cndmask_b32 v21, v22, v23, vcc
    v_bfe_u32 v22, v0, 1, 2
    v_cmp_eq_u32 vcc, 0, v22
    s_nop 1
    v_cndmask_b32 v2, 0, v21, vcc
    v_cmp_eq_u32 vcc, 1, v22
    s_nop 1
    v_cndmask_b32 v3, 0, v21, vcc
    v_cmp_eq_u32 vcc, 2, v22
    s_nop 1
    v_cndmask_b32 v4, 0, v21, vcc
    v_cmp_eq_u32 vcc, 3, v22
    s_nop 1
    v_cndmask_b32 v5, 0, v21, vcc
    s_add_u32 s9, s3, 0
    s_mul_i32 s10, s9, 60
    v_bfe_u32 v21, v0, 4, 2
    v_mul_u32_u24 v22, 15, v21
    v_and_b32 v53, 15, v0
    v_add3_u32 v22, v22, v53, s10
    v_cmp_gt_u32 vcc, 15, v53
    v_mov_b32 v54, 0x3ff
    s_nop 0
    v_cndmask_b32 v22, v54, v22, vcc
    s_lshl_b32 s9, s9, 2
    s_add_u32 s9, s9, s5
    s_lshl_b32 s9, s9, 12
    s_add_u32 s9, s9, 524288
    v_lshlrev_b32 v53, 2, v53
    v_lshl_add_u32 v53, v21, 7, v53
    v_add_u32 v53, s9, v53
    s_mul_i32 s9, s5, 1280
    v_lshl_add_u32 v54, v22, 1, s9
    v_cmp_gt_u32 vcc, 640, v22
    v_mov_b32 v21, 0x7fff0000
    s_nop 0
    v_cndmask_b32 v54, v21, v54, vcc
    v_cndmask_b32 v22, 0, v22, vcc
    s_mov_b64 s[92:93], vcc
    v_lshrrev_b32 v52, 5, v22
    v_lshlrev_b32 v52, 8, v52
    v_and_b32 v21, 7, v22
    v_lshl_add_u32 v52, v21, 4, v52
    v_bfe_u32 v21, v22, 3, 2
    v_lshl_add_u32 v52, v21, 2, v52
    v_add_u32 v52, 31040, v52
    s_add_u32 s9, s3, 4
    s_mul_i32 s10, s9, 60
    v_bfe_u32 v21, v0, 4, 2
    v_mul_u32_u24 v22, 15, v21
    v_and_b32 v57, 15, v0
    v_add3_u32 v22, v22, v57, s10
    v_cmp_gt_u32 vcc, 15, v57
    v_mov_b32 v58, 0x3ff
    s_nop 0
    v_cndmask_b32 v22, v58, v22, vcc
    s_lshl_b32 s9, s9, 2
    s_add_u32 s9, s9, s5
    s_lshl_b32 s9, s9, 12
    s_add_u32 s9, s9, 524288
    v_lshlrev_b32 v57, 2, v57
    v_lshl_add_u32 v57, v21, 7, v57
    v_add_u32 v57, s9, v57
    s_mul_i32 s9, s5, 1280
    v_lshl_add_u32 v58, v22, 1, s9
    v_cmp_gt_u32 vcc, 640, v22
    v_mov_b32 v21, 0x7fff0000
    s_nop 0
    v_cndmask_b32 v58, v21, v58, vcc
    v_cndmask_b32 v22, 0, v22, vcc
    s_mov_b64 s[94:95], vcc
    v_lshrrev_b32 v56, 5, v22
    v_lshlrev_b32 v56, 8, v56
    v_and_b32 v21, 7, v22
    v_lshl_add_u32 v56, v21, 4, v56
    v_bfe_u32 v21, v22, 3, 2
    v_lshl_add_u32 v56, v21, 2, v56
    v_add_u32 v56, 31040, v56
    s_cmp_eq_u32 s3, 7
    s_cselect_b32 s9, 0x7fff0000, 0
    v_or_b32 v57, s9, v57
    v_and_b32 v21, 7, v0
    v_bfe_u32 v22, v0, 4, 2
    v_lshl_add_u32 v21, v22, 3, v21
    s_lshl_b32 s9, s15, 9
    v_lshl_add_u32 v11, v21, 4, s9
    v_and_b32 v28, 15, v0
    v_lshlrev_b32 v28, 4, v28
    s_and_b32 s82, s2, 7
    s_lshl_b32 s82, s82, 8
    s_add_u32 s82, s82, 753664
    s_and_b32 s83, s2, -8
    s_add_u32 s83, s83, s82
    v_and_b32 v34, 31, v0
    v_lshlrev_b32 v34, 3, v34
    s_barrier
    s_waitcnt vmcnt(4)
    buffer_load_dwordx4 v[84:87], v1, s[40:43], s8 offen offset:1024 nt
    s_waitcnt vmcnt(4)
    buffer_load_dwordx4 v[88:91], v1, s[40:43], s8 offen offset:2048 nt
    s_waitcnt vmcnt(4)
    buffer_load_dwordx4 v[92:95], v1, s[40:43], s8 offen offset:3072 nt
    s_waitcnt vmcnt(4)
    s_mov_b32 s8, 65536
    buffer_load_dwordx4 v[96:99], v1, s[40:43], s8 offen offset:0 nt
    s_waitcnt vmcnt(4)
    buffer_load_dwordx4 v[100:103], v1, s[40:43], s8 offen offset:1024 nt
    s_waitcnt vmcnt(4)
    buffer_load_dwordx4 v[104:107], v1, s[40:43], s8 offen offset:2048 nt
    s_waitcnt vmcnt(4)
    buffer_load_dwordx4 v[108:111], v1, s[40:43], s8 offen offset:3072 nt
    s_waitcnt vmcnt(4)
    s_mov_b32 s8, 81920
    buffer_load_dwordx4 v[112:115], v1, s[40:43], s8 offen offset:0 nt
    s_waitcnt vmcnt(4)
    buffer_load_dwordx4 v[116:119], v1, s[40:43], s8 offen offset:1024 nt
    s_waitcnt vmcnt(4)
    buffer_load_dwordx4 v[120:123], v1, s[40:43], s8 offen offset:2048 nt
    s_waitcnt vmcnt(4)
    buffer_load_dwordx4 v[124:127], v1, s[40:43], s8 offen offset:3072 nt
    s_waitcnt vmcnt(4)
    s_mov_b32 s8, 131072
    buffer_load_dwordx4 v[128:131], v1, s[40:43], s8 offen offset:0 nt
    s_waitcnt vmcnt(4)
    buffer_load_dwordx4 v[132:135], v1, s[40:43], s8 offen offset:1024 nt
    s_waitcnt vmcnt(4)
    buffer_load_dwordx4 v[136:139], v1, s[40:43], s8 offen offset:2048 nt
    s_waitcnt vmcnt(4)
    buffer_load_dwordx4 v[140:143], v1, s[40:43], s8 offen offset:3072 nt
    s_waitcnt vmcnt(4)
    s_mov_b32 s8, 147456
    buffer_load_dwordx4 v[144:147], v1, s[40:43], s8 offen offset:0 nt
    s_waitcnt vmcnt(4)
    buffer_load_dwordx4 v[148:151], v1, s[40:43], s8 offen offset:1024 nt
    s_waitcnt vmcnt(4)
    buffer_load_dwordx4 v[152:155], v1, s[40:43], s8 offen offset:2048 nt
    s_waitcnt vmcnt(4)
    buffer_load_dwordx4 v[156:159], v1, s[40:43], s8 offen offset:3072 nt
    s_waitcnt vmcnt(4)
    s_mov_b32 s8, 196608
    buffer_load_dwordx4 v[160:163], v1, s[40:43], s8 offen offset:0 nt
    s_waitcnt vmcnt(4)
    buffer_load_dwordx4 v[164:167], v1, s[40:43], s8 offen offset:1024 nt
    s_waitcnt vmcnt(4)
    buffer_load_dwordx4 v[168:171], v1, s[40:43], s8 offen offset:2048 nt
    s_waitcnt vmcnt(4)
    buffer_load_dwordx4 v[172:175], v1, s[40:43], s8 offen offset:3072 nt
    s_waitcnt vmcnt(4)
    s_mov_b32 s8, 212992
    buffer_load_dwordx4 v[176:179], v1, s[40:43], s8 offen offset:0 nt
    s_waitcnt vmcnt(4)
    buffer_load_dwordx4 v[180:183], v1, s[40:43], s8 offen offset:1024 nt
    s_waitcnt vmcnt(4)
    buffer_load_dwordx4 v[184:187], v1, s[40:43], s8 offen offset:2048 nt
    s_waitcnt vmcnt(4)
    buffer_load_dwordx4 v[188:191], v1, s[40:43], s8 offen offset:3072 nt
    s_waitcnt vmcnt(4)
    s_mov_b32 s8, 262144
    buffer_load_dwordx4 v[192:195], v1, s[40:43], s8 offen offset:0 nt
    s_waitcnt vmcnt(4)
    buffer_load_dwordx4 v[196:199], v1, s[40:43], s8 offen offset:1024 nt
    s_waitcnt vmcnt(4)
    buffer_load_dwordx4 v[200:203], v1, s[40:43], s8 offen offset:2048 nt
    s_waitcnt vmcnt(4)
    buffer_load_dwordx4 v[204:207], v1, s[40:43], s8 offen offset:3072 nt
    s_waitcnt vmcnt(4)
    s_mov_b32 s8, 278528
    buffer_load_dwordx4 v[208:211], v1, s[40:43], s8 offen offset:0 nt
    s_waitcnt vmcnt(4)
    buffer_load_dwordx4 v[212:215], v1, s[40:43], s8 offen offset:1024 nt
    s_waitcnt vmcnt(4)
    buffer_load_dwordx4 v[216:219], v1, s[40:43], s8 offen offset:2048 nt
    s_waitcnt vmcnt(4)
    buffer_load_dwordx4 v[220:223], v1, s[40:43], s8 offen offset:3072 nt
    s_waitcnt vmcnt(4)
    s_mov_b32 s8, 327680
    buffer_load_dwordx4 v[224:227], v1, s[40:43], s8 offen offset:0 nt
    s_waitcnt vmcnt(4)
    buffer_load_dwordx4 v[228:231], v1, s[40:43], s8 offen offset:1024 nt
    s_waitcnt vmcnt(4)
    buffer_load_dwordx4 v[232:235], v1, s[40:43], s8 offen offset:2048 nt
    s_waitcnt vmcnt(4)
    buffer_load_dwordx4 v[236:239], v1, s[40:43], s8 offen offset:3072 nt
    s_waitcnt vmcnt(4)
    s_mov_b32 s8, 344064
    buffer_load_dwordx4 v[240:243], v1, s[40:43], s8 offen offset:0 nt
    s_waitcnt vmcnt(4)
    buffer_load_dwordx4 v[244:247], v1, s[40:43], s8 offen offset:1024 nt
    s_waitcnt vmcnt(4)
    buffer_load_dwordx4 v[248:251], v1, s[40:43], s8 offen offset:2048 nt
    s_waitcnt vmcnt(4)
    buffer_load_dwordx4 v[252:255], v1, s[40:43], s8 offen offset:3072 nt
    s_mov_b32 s9, 0x2000000
L_sp1:
    ds_read_b32 v29, v8 offset:27464
    ds_read_b128 v[36:39], v28 offset:18432
    ds_read_b32 v30, v8 offset:26928
    s_waitcnt lgkmcnt(0)
    v_readfirstlane_b32 s10, v29
    s_nop 0
    s_cmp_ge_u32 s10, 1
    s_cbranch_scc1 L_spd2
    s_sub_u32 s9, s9, 1
    s_cmp_eq_u32 s9, 0
    s_cbranch_scc1 L_spd2
    s_sleep 1
    s_branch L_sp1
L_spd2:
    v_readfirstlane_b32 s90, v30
    v_mov_b32 v20, 0
    v_dot2c_f32_bf16 v20, v64, v36
    v_dot2c_f32_bf16 v20, v65, v37
    v_dot2c_f32_bf16 v20, v66, v38
    v_dot2c_f32_bf16 v20, v67, v39
    s_waitcnt vmcnt(4)
    s_mov_b32 s8, 393216
    buffer_load_dwordx4 v[64:67], v1, s[40:43], s8 offen offset:0 nt
    v_mov_b32 v21, 0
    v_dot2c_f32_bf16 v21, v68, v36
    v_dot2c_f32_bf16 v21, v69, v37
    v_dot2c_f32_bf16 v21, v70, v38
    v_dot2c_f32_bf16 v21, v71, v39
    s_waitcnt vmcnt(4)
    buffer_load_dwordx4 v[68:71], v1, s[40:43], s8 offen offset:1024 nt
    v_add_f32_dpp v22, v20, v20 row_shl:8 row_mask:0xf bank_mask:0x3
    v_add_f32_dpp v22, v21, v21 row_shr:8 row_mask:0xf bank_mask:0xc
    v_mov_b32 v20, 0
    v_dot2c_f32_bf16 v20, v72, v36
    v_dot2c_f32_bf16 v20, v73, v37
    v_dot2c_f32_bf16 v20, v74, v38
    v_dot2c_f32_bf16 v20, v75, v39
    s_waitcnt vmcnt(4)
    buffer_load_dwordx4 v[72:75], v1, s[40:43], s8 offen offset:2048 nt
    v_mov_b32 v21, 0
    v_dot2c_f32_bf16 v21, v76, v36
    v_dot2c_f32_bf16 v21, v77, v37
    v_dot2c_f32_bf16 v21, v78, v38
    v_dot2c_f32_bf16 v21, v79, v39
    s_waitcnt vmcnt(4)
    buffer_load_dwordx4 v[76:79], v1, s[40:43], s8 offen offset:3072 nt
    v_add_f32_dpp v23, v20, v20 row_shl:8 row_mask:0xf bank_mask:0x3
    v_add_f32_dpp v23, v21, v21 row_shr:8 row_mask:0xf bank_mask:0xc
    v_add_f32_dpp v24, v22, v22 row_shl:4 row_mask:0xf bank_mask:0x5
    s_nop 0
    v_add_f32_dpp v24, v23, v23 row_shr:4 row_mask:0xf bank_mask:0xa
    s_nop 1
    v_add_f32_dpp v24, v24, v24 quad_perm:[2,3,0,1] row_mask:0xf bank_mask:0xf
    v_mov_b32 v20, 0
    v_dot2c_f32_bf16 v20, v80, v36
    v_dot2c_f32_bf16 v20, v81, v37
    v_dot2c_f32_bf16 v20, v82, v38
    v_dot2c_f32_bf16 v20, v83, v39
    s_waitcnt vmcnt(4)
    s_mov_b32 s8, 409600
    buffer_load_dwordx4 v[80:83], v1, s[40:43], s8 offen offset:0 nt
    v_mov_b32 v21, 0
    v_dot2c_f32_bf16 v21, v84, v36
    v_dot2c_f32_bf16 v21, v85, v37
    v_dot2c_f32_bf16 v21, v86, v38
    v_dot2c_f32_bf16 v21, v87, v39
    v_add_f32_dpp v22, v20, v20 row_shl:8 row_mask:0xf bank_mask:0x3
    s_nop 1
    v_add_f32_dpp v22, v21, v21 row_shr:8 row_mask:0xf bank_mask:0xc
    v_mov_b32 v20, 0
    v_dot2c_f32_bf16 v20, v88, v36
    v_dot2c_f32_bf16 v20, v89, v37
    v_dot2c_f32_bf16 v20, v90, v38
    v_dot2c_f32_bf16 v20, v91, v39
    v_mov_b32 v21, 0
    v_dot2c_f32_bf16 v21, v92, v36
    v_dot2c_f32_bf16 v21, v93, v37
    v_dot2c_f32_bf16 v21, v94, v38
    v_dot2c_f32_bf16 v21, v95, v39
    s_waitcnt vmcnt(4)
    buffer_load_dwordx4 v[84:87], v1, s[40:43], s8 offen offset:1024 nt
    v_add_f32_dpp v23, v20, v20 row_shl:8 row_mask:0xf bank_mask:0x3
    v_add_f32_dpp v23, v21, v21 row_shr:8 row_mask:0xf bank_mask:0xc
    v_add_f32_dpp v25, v22, v22 row_shl:4 row_mask:0xf bank_mask:0x5
    s_nop 0
    v_add_f32_dpp v25, v23, v23 row_shr:4 row_mask:0xf bank_mask:0xa
    s_nop 1
    v_add_f32_dpp v25, v25, v25 quad_perm:[2,3,0,1] row_mask:0xf bank_mask:0xf
    v_cndmask_b32 v26, v24, v25, s[86:87]
    s_nop 1
    v_add_f32_dpp v26, v26, v26 quad_perm:[1,0,3,2] row_mask:0xf bank_mask:0xf
    v_mov_b32 v20, 0
    v_dot2c_f32_bf16 v20, v96, v36
    v_dot2c_f32_bf16 v20, v97, v37
    v_dot2c_f32_bf16 v20, v98, v38
    v_dot2c_f32_bf16 v20, v99, v39
    v_mov_b32 v21, 0
    v_dot2c_f32_bf16 v21, v100, v36
    v_dot2c_f32_bf16 v21, v101, v37
    v_dot2c_f32_bf16 v21, v102, v38
    v_dot2c_f32_bf16 v21, v103, v39
    v_add_f32_dpp v22, v20, v20 row_shl:8 row_mask:0xf bank_mask:0x3
    s_nop 1
    v_add_f32_dpp v22, v21, v21 row_shr:8 row_mask:0xf bank_mask:0xc
    v_mov_b32 v20, 0
    v_dot2c_f32_bf16 v20, v104, v36
    v_dot2c_f32_bf16 v20, v105, v37
    v_dot2c_f32_bf16 v20, v106, v38
    v_dot2c_f32_bf16 v20, v107, v39
    s_waitcnt vmcnt(4)
    buffer_load_dwordx4 v[88:91], v1, s[40:43], s8 offen offset:2048 nt
    v_mov_b32 v21, 0
    v_dot2c_f32_bf16 v21, v108, v36
    v_dot2c_f32_bf16 v21, v109, v37
    v_dot2c_f32_bf16 v21, v110, v38
    v_dot2c_f32_bf16 v21, v111, v39
    v_add_f32_dpp v23, v20, v20 row_shl:8 row_mask:0xf bank_mask:0x3
    s_nop 1
    v_add_f32_dpp v23, v21, v21 row_shr:8 row_mask:0xf bank_mask:0xc
    v_add_f32_dpp v24, v22, v22 row_shl:4 row_mask:0xf bank_mask:0x5
    s_nop 0
    v_add_f32_dpp v24, v23, v23 row_shr:4 row_mask:0xf bank_mask:0xa
    s_nop 1
    v_add_f32_dpp v24, v24, v24 quad_perm:[2,3,0,1] row_mask:0xf bank_mask:0xf
    v_mov_b32 v20, 0
    v_dot2c_f32_bf16 v20, v112, v36
    v_dot2c_f32_bf16 v20, v113, v37
    v_dot2c_f32_bf16 v20, v114, v38
    v_dot2c_f32_bf16 v20, v115, v39
    v_mov_b32 v21, 0
    v_dot2c_f32_bf16 v21, v116, v36
    v_dot2c_f32_bf16 v21, v117, v37
    v_dot2c_f32_bf16 v21, v118, v38
    v_dot2c_f32_bf16 v21, v119, v39
    s_waitcnt vmcnt(4)
    buffer_load_dwordx4 v[92:95], v1, s[40:43], s8 offen offset:3072 nt
    v_add_f32_dpp v22, v20, v20 row_shl:8 row_mask:0xf bank_mask:0x3
    v_add_f32_dpp v22, v21, v21 row_shr:8 row_mask:0xf bank_mask:0xc
    v_mov_b32 v20, 0
    v_dot2c_f32_bf16 v20, v120, v36
    v_dot2c_f32_bf16 v20, v121, v37
    v_dot2c_f32_bf16 v20, v122, v38
    v_dot2c_f32_bf16 v20, v123, v39
    v_mov_b32 v21, 0
    v_dot2c_f32_bf16 v21, v124, v36
    v_dot2c_f32_bf16 v21, v125, v37
    v_dot2c_f32_bf16 v21, v126, v38
    v_dot2c_f32_bf16 v21, v127, v39
    v_add_f32_dpp v23, v20, v20 row_shl:8 row_mask:0xf bank_mask:0x3
    s_nop 1
    v_add_f32_dpp v23, v21, v21 row_shr:8 row_mask:0xf bank_mask:0xc
    v_add_f32_dpp v25, v22, v22 row_shl:4 row_mask:0xf bank_mask:0x5
    s_nop 0
    v_add_f32_dpp v25, v23, v23 row_shr:4 row_mask:0xf bank_mask:0xa
    s_nop 1
    v_add_f32_dpp v25, v25, v25 quad_perm:[2,3,0,1] row_mask:0xf bank_mask:0xf
    v_cndmask_b32 v27, v24, v25, s[86:87]
    s_nop 1
    v_add_f32_dpp v27, v27, v27 quad_perm:[1,0,3,2] row_mask:0xf bank_mask:0xf
    v_cndmask_b32 v44, v26, v27, s[88:89]
    v_mov_b32 v20, 0
    v_dot2c_f32_bf16 v20, v128, v36
    v_dot2c_f32_bf16 v20, v129, v37
    v_dot2c_f32_bf16 v20, v130, v38
    v_dot2c_f32_bf16 v20, v131, v39
    s_waitcnt vmcnt(4)
    s_mov_b32 s8, 458752
    buffer_load_dwordx4 v[96:99], v1, s[40:43], s8 offen offset:0 nt
    v_mov_b32 v21, 0
    v_dot2c_f32_bf16 v21, v132, v36
    v_dot2c_f32_bf16 v21, v133, v37
    v_dot2c_f32_bf16 v21, v134, v38
    v_dot2c_f32_bf16 v21, v135, v39
    v_add_f32_dpp v22, v20, v20 row_shl:8 row_mask:0xf bank_mask:0x3
    s_nop 1
    v_add_f32_dpp v22, v21, v21 row_shr:8 row_mask:0xf bank_mask:0xc
    v_mov_b32 v20, 0
    v_dot2c_f32_bf16 v20, v136, v36
    v_dot2c_f32_bf16 v20, v137, v37
    v_dot2c_f32_bf16 v20, v138, v38
    v_dot2c_f32_bf16 v20, v139, v39
    v_mov_b32 v21, 0
    v_dot2c_f32_bf16 v21, v140, v36
    v_dot2c_f32_bf16 v21, v141, v37
    v_dot2c_f32_bf16 v21, v142, v38
    v_dot2c_f32_bf16 v21, v143, v39
    s_waitcnt vmcnt(4)
    buffer_load_dwordx4 v[100:103], v1, s[40:43], s8 offen offset:1024 nt
    v_add_f32_dpp v23, v20, v20 row_shl:8 row_mask:0xf bank_mask:0x3
    v_add_f32_dpp v23, v21, v21 row_shr:8 row_mask:0xf bank_mask:0xc
    v_add_f32_dpp v24, v22, v22 row_shl:4 row_mask:0xf bank_mask:0x5
    s_nop 0
    v_add_f32_dpp v24, v23, v23 row_shr:4 row_mask:0xf bank_mask:0xa
    s_nop 1
    v_add_f32_dpp v24, v24, v24 quad_perm:[2,3,0,1] row_mask:0xf bank_mask:0xf
    v_mov_b32 v20, 0
    v_dot2c_f32_bf16 v20, v144, v36
    v_dot2c_f32_bf16 v20, v145, v37
    v_dot2c_f32_bf16 v20, v146, v38
    v_dot2c_f32_bf16 v20, v147, v39
    v_mov_b32 v21, 0
    v_dot2c_f32_bf16 v21, v148, v36
    v_dot2c_f32_bf16 v21, v149, v37
    v_dot2c_f32_bf16 v21, v150, v38
    v_dot2c_f32_bf16 v21, v151, v39
    v_add_f32_dpp v22, v20, v20 row_shl:8 row_mask:0xf bank_mask:0x3
    s_nop 1
    v_add_f32_dpp v22, v21, v21 row_shr:8 row_mask:0xf bank_mask:0xc
    v_mov_b32 v20, 0
    v_dot2c_f32_bf16 v20, v152, v36
    v_dot2c_f32_bf16 v20, v153, v37
    v_dot2c_f32_bf16 v20, v154, v38
    v_dot2c_f32_bf16 v20, v155, v39
    s_waitcnt vmcnt(4)
    buffer_load_dwordx4 v[104:107], v1, s[40:43], s8 offen offset:2048 nt
    v_mov_b32 v21, 0
    v_dot2c_f32_bf16 v21, v156, v36
    v_dot2c_f32_bf16 v21, v157, v37
    v_dot2c_f32_bf16 v21, v158, v38
    v_dot2c_f32_bf16 v21, v159, v39
    v_add_f32_dpp v23, v20, v20 row_shl:8 row_mask:0xf bank_mask:0x3
    s_nop 1
    v_add_f32_dpp v23, v21, v21 row_shr:8 row_mask:0xf bank_mask:0xc
    v_add_f32_dpp v25, v22, v22 row_shl:4 row_mask:0xf bank_mask:0x5
    s_nop 0
    v_add_f32_dpp v25, v23, v23 row_shr:4 row_mask:0xf bank_mask:0xa
    s_nop 1
    v_add_f32_dpp v25, v25, v25 quad_perm:[2,3,0,1] row_mask:0xf bank_mask:0xf
    v_cndmask_b32 v26, v24, v25, s[86:87]
    s_nop 1
    v_add_f32_dpp v26, v26, v26 quad_perm:[1,0,3,2] row_mask:0xf bank_mask:0xf
    v_mov_b32 v20, 0
    v_dot2c_f32_bf16 v20, v160, v36
    v_dot2c_f32_bf16 v20, v161, v37
    v_dot2c_f32_bf16 v20, v162, v38
    v_dot2c_f32_bf16 v20, v163, v39
    v_mov_b32 v21, 0
    v_dot2c_f32_bf16 v21, v164, v36
    v_dot2c_f32_bf16 v21, v165, v37
    v_dot2c_f32_bf16 v21, v166, v38
    v_dot2c_f32_bf16 v21, v167, v39
    s_waitcnt vmcnt(4)
    buffer_load_dwordx4 v[108:111], v1, s[40:43], s8 offen offset:3072 nt
    v_add_f32_dpp v22, v20, v20 row_shl:8 row_mask:0xf bank_mask:0x3
    v_add_f32_dpp v22, v21, v21 row_shr:8 row_mask:0xf bank_mask:0xc
    v_mov_b32 v20, 0
    v_dot2c_f32_bf16 v20, v168, v36
    v_dot2c_f32_bf16 v20, v169, v37
    v_dot2c_f32_bf16 v20, v170, v38
    v_dot2c_f32_bf16 v20, v171, v39
    v_mov_b32 v21, 0
    v_dot2c_f32_bf16 v21, v172, v36
    v_dot2c_f32_bf16 v21, v173, v37
    v_dot2c_f32_bf16 v21, v174, v38
    v_dot2c_f32_bf16 v21, v175, v39
    v_add_f32_dpp v23, v20, v20 row_shl:8 row_mask:0xf bank_mask:0x3
    s_nop 1
    v_add_f32_dpp v23, v21, v21 row_shr:8 row_mask:0xf bank_mask:0xc
    v_add_f32_dpp v24, v22, v22 row_shl:4 row_mask:0xf bank_mask:0x5
    s_nop 0
    v_add_f32_dpp v24, v23, v23 row_shr:4 row_mask:0xf bank_mask:0xa
    s_nop 1
    v_add_f32_dpp v24, v24, v24 quad_perm:[2,3,0,1] row_mask:0xf bank_mask:0xf
    v_mov_b32 v20, 0
    v_dot2c_f32_bf16 v20, v176, v36
    v_dot2c_f32_bf16 v20, v177, v37
    v_dot2c_f32_bf16 v20, v178, v38
    v_dot2c_f32_bf16 v20, v179, v39
    s_waitcnt vmcnt(4)
    s_mov_b32 s8, 475136
    buffer_load_dwordx4 v[112:115], v1, s[40:43], s8 offen offset:0 nt
    v_mov_b32 v21, 0
    v_dot2c_f32_bf16 v21, v180, v36
    v_dot2c_f32_bf16 v21, v181, v37
    v_dot2c_f32_bf16 v21, v182, v38
    v_dot2c_f32_bf16 v21, v183, v39
    v_add_f32_dpp v22, v20, v20 row_shl:8 row_mask:0xf bank_mask:0x3
    s_nop 1
    v_add_f32_dpp v22, v21, v21 row_shr:8 row_mask:0xf bank_mask:0xc
    v_mov_b32 v20, 0
    v_dot2c_f32_bf16 v20, v184, v36
    v_dot2c_f32_bf16 v20, v185, v37
    v_dot2c_f32_bf16 v20, v186, v38
    v_dot2c_f32_bf16 v20, v187, v39
    v_mov_b32 v21, 0
    v_dot2c_f32_bf16 v21, v188, v36
    v_dot2c_f32_bf16 v21, v189, v37
    v_dot2c_f32_bf16 v21, v190, v38
    v_dot2c_f32_bf16 v21, v191, v39
    s_waitcnt vmcnt(4)
    buffer_load_dwordx4 v[116:119], v1, s[40:43], s8 offen offset:1024 nt
    v_add_f32_dpp v23, v20, v20 row_shl:8 row_mask:0xf bank_mask:0x3
    v_add_f32_dpp v23, v21, v21 row_shr:8 row_mask:0xf bank_mask:0xc
    v_add_f32_dpp v25, v22, v22 row_shl:4 row_mask:0xf bank_mask:0x5
    s_nop 0
    v_add_f32_dpp v25, v23, v23 row_shr:4 row_mask:0xf bank_mask:0xa
    s_nop 1
    v_add_f32_dpp v25, v25, v25 quad_perm:[2,3,0,1] row_mask:0xf bank_mask:0xf
    v_cndmask_b32 v27, v24, v25, s[86:87]
    s_nop 1
    v_add_f32_dpp v27, v27, v27 quad_perm:[1,0,3,2] row_mask:0xf bank_mask:0xf
    v_cndmask_b32 v45, v26, v27, s[88:89]
    v_mov_b32 v20, 0
    v_dot2c_f32_bf16 v20, v192, v36
    v_dot2c_f32_bf16 v20, v193, v37
    v_dot2c_f32_bf16 v20, v194, v38
    v_dot2c_f32_bf16 v20, v195, v39
    v_mov_b32 v21, 0
    v_dot2c_f32_bf16 v21, v196, v36
    v_dot2c_f32_bf16 v21, v197, v37
    v_dot2c_f32_bf16 v21, v198, v38
    v_dot2c_f32_bf16 v21, v199, v39
    v_add_f32_dpp v22, v20, v20 row_shl:8 row_mask:0xf bank_mask:0x3
    s_nop 1
    v_add_f32_dpp v22, v21, v21 row_shr:8 row_mask:0xf bank_mask:0xc
    v_mov_b32 v20, 0
    v_dot2c_f32_bf16 v20, v200, v36
    v_dot2c_f32_bf16 v20, v201, v37
    v_dot2c_f32_bf16 v20, v202, v38
    v_dot2c_f32_bf16 v20, v203, v39
    s_waitcnt vmcnt(4)
    buffer_load_dwordx4 v[120:123], v1, s[40:43], s8 offen offset:2048 nt
    v_mov_b32 v21, 0
    v_dot2c_f32_bf16 v21, v204, v36
    v_dot2c_f32_bf16 v21, v205, v37
    v_dot2c_f32_bf16 v21, v206, v38
    v_dot2c_f32_bf16 v21, v207, v39
    v_add_f32_dpp v23, v20, v20 row_shl:8 row_mask:0xf bank_mask:0x3
    s_nop 1
    v_add_f32_dpp v23, v21, v21 row_shr:8 row_mask:0xf bank_mask:0xc
    v_add_f32_dpp v24, v22, v22 row_shl:4 row_mask:0xf bank_mask:0x5
    s_nop 0
    v_add_f32_dpp v24, v23, v23 row_shr:4 row_mask:0xf bank_mask:0xa
    s_nop 1
    v_add_f32_dpp v24, v24, v24 quad_perm:[2,3,0,1] row_mask:0xf bank_mask:0xf
    v_mov_b32 v20, 0
    v_dot2c_f32_bf16 v20, v208, v36
    v_dot2c_f32_bf16 v20, v209, v37
    v_dot2c_f32_bf16 v20, v210, v38
    v_dot2c_f32_bf16 v20, v211, v39
    v_mov_b32 v21, 0
    v_dot2c_f32_bf16 v21, v212, v36
    v_dot2c_f32_bf16 v21, v213, v37
    v_dot2c_f32_bf16 v21, v214, v38
    v_dot2c_f32_bf16 v21, v215, v39
    s_waitcnt vmcnt(4)
    buffer_load_dwordx4 v[124:127], v1, s[40:43], s8 offen offset:3072 nt
    v_add_f32_dpp v22, v20, v20 row_shl:8 row_mask:0xf bank_mask:0x3
    v_add_f32_dpp v22, v21, v21 row_shr:8 row_mask:0xf bank_mask:0xc
    v_mov_b32 v20, 0
    v_dot2c_f32_bf16 v20, v216, v36
    v_dot2c_f32_bf16 v20, v217, v37
    v_dot2c_f32_bf16 v20, v218, v38
    v_dot2c_f32_bf16 v20, v219, v39
    v_mov_b32 v21, 0
    v_dot2c_f32_bf16 v21, v220, v36
    v_dot2c_f32_bf16 v21, v221, v37
    v_dot2c_f32_bf16 v21, v222, v38
    v_dot2c_f32_bf16 v21, v223, v39
    v_add_f32_dpp v23, v20, v20 row_shl:8 row_mask:0xf bank_mask:0x3
    s_nop 1
    v_add_f32_dpp v23, v21, v21 row_shr:8 row_mask:0xf bank_mask:0xc
    v_add_f32_dpp v25, v22, v22 row_shl:4 row_mask:0xf bank_mask:0x5
    s_nop 0
    v_add_f32_dpp v25, v23, v23 row_shr:4 row_mask:0xf bank_mask:0xa
    s_nop 1
    v_add_f32_dpp v25, v25, v25 quad_perm:[2,3,0,1] row_mask:0xf bank_mask:0xf
    v_cndmask_b32 v26, v24, v25, s[86:87]
    s_nop 1
    v_add_f32_dpp v26, v26, v26 quad_perm:[1,0,3,2] row_mask:0xf bank_mask:0xf
    v_mov_b32 v20, 0
    v_dot2c_f32_bf16 v20, v224, v36
    v_dot2c_f32_bf16 v20, v225, v37
    v_dot2c_f32_bf16 v20, v226, v38
    v_dot2c_f32_bf16 v20, v227, v39
    s_waitcnt vmcnt(4)
    s_mov_b32 s8, 524288
    buffer_load_dwordx4 v[128:131], v1, s[40:43], s8 offen offset:0 nt
    v_mov_b32 v21, 0
    v_dot2c_f32_bf16 v21, v228, v36
    v_dot2c_f32_bf16 v21, v229, v37
    v_dot2c_f32_bf16 v21, v230, v38
    v_dot2c_f32_bf16 v21, v231, v39
    v_add_f32_dpp v22, v20, v20 row_shl:8 row_mask:0xf bank_mask:0x3
    s_nop 1
    v_add_f32_dpp v22, v21, v21 row_shr:8 row_mask:0xf bank_mask:0xc
    v_mov_b32 v20, 0
    v_dot2c_f32_bf16 v20, v232, v36
    v_dot2c_f32_bf16 v20, v233, v37
    v_dot2c_f32_bf16 v20, v234, v38
    v_dot2c_f32_bf16 v20, v235, v39
    v_mov_b32 v21, 0
    v_dot2c_f32_bf16 v21, v236, v36
    v_dot2c_f32_bf16 v21, v237, v37
    v_dot2c_f32_bf16 v21, v238, v38
    v_dot2c_f32_bf16 v21, v239, v39
    s_waitcnt vmcnt(4)
    buffer_load_dwordx4 v[132:135], v1, s[40:43], s8 offen offset:1024 nt
    v_add_f32_dpp v23, v20, v20 row_shl:8 row_mask:0xf bank_mask:0x3
    v_add_f32_dpp v23, v21, v21 row_shr:8 row_mask:0xf bank_mask:0xc
    v_add_f32_dpp v24, v22, v22 row_shl:4 row_mask:0xf bank_mask:0x5
    s_nop 0
    v_add_f32_dpp v24, v23, v23 row_shr:4 row_mask:0xf bank_mask:0xa
    s_nop 1
    v_add_f32_dpp v24, v24, v24 quad_perm:[2,3,0,1] row_mask:0xf bank_mask:0xf
    v_mov_b32 v20, 0
    v_dot2c_f32_bf16 v20, v240, v36
    v_dot2c_f32_bf16 v20, v241, v37
    v_dot2c_f32_bf16 v20, v242, v38
    v_dot2c_f32_bf16 v20, v243, v39
    v_mov_b32 v21, 0
    v_dot2c_f32_bf16 v21, v244, v36
    v_dot2c_f32_bf16 v21, v245, v37
    v_dot2c_f32_bf16 v21, v246, v38
    v_dot2c_f32_bf16 v21, v247, v39
    v_add_f32_dpp v22, v20, v20 row_shl:8 row_mask:0xf bank_mask:0x3
    s_nop 1
    v_add_f32_dpp v22, v21, v21 row_shr:8 row_mask:0xf bank_mask:0xc
    v_mov_b32 v20, 0
    v_dot2c_f32_bf16 v20, v248, v36
    v_dot2c_f32_bf16 v20, v249, v37
    v_dot2c_f32_bf16 v20, v250, v38
    v_dot2c_f32_bf16 v20, v251, v39
    s_waitcnt vmcnt(4)
    buffer_load_dwordx4 v[136:139], v1, s[40:43], s8 offen offset:2048 nt
    v_mov_b32 v21, 0
    v_dot2c_f32_bf16 v21, v252, v36
    v_dot2c_f32_bf16 v21, v253, v37
    v_dot2c_f32_bf16 v21, v254, v38
    v_dot2c_f32_bf16 v21, v255, v39
    v_add_f32_dpp v23, v20, v20 row_shl:8 row_mask:0xf bank_mask:0x3
    s_nop 1
    v_add_f32_dpp v23, v21, v21 row_shr:8 row_mask:0xf bank_mask:0xc
    v_add_f32_dpp v25, v22, v22 row_shl:4 row_mask:0xf bank_mask:0x5
    s_nop 0
    v_add_f32_dpp v25, v23, v23 row_shr:4 row_mask:0xf bank_mask:0xa
    s_nop 1
    v_add_f32_dpp v25, v25, v25 quad_perm:[2,3,0,1] row_mask:0xf bank_mask:0xf
    v_cndmask_b32 v27, v24, v25, s[86:87]
    s_nop 1
    v_add_f32_dpp v27, v27, v27 quad_perm:[1,0,3,2] row_mask:0xf bank_mask:0xf
    v_cndmask_b32 v46, v26, v27, s[88:89]
    v_mov_b32 v20, 0
    v_dot2c_f32_bf16 v20, v64, v36
    v_dot2c_f32_bf16 v20, v65, v37
    v_dot2c_f32_bf16 v20, v66, v38
    v_dot2c_f32_bf16 v20, v67, v39
    v_mov_b32 v21, 0
    v_dot2c_f32_bf16 v21, v68, v36
    v_dot2c_f32_bf16 v21, v69, v37
    v_dot2c_f32_bf16 v21, v70, v38
    v_dot2c_f32_bf16 v21, v71, v39
    s_waitcnt vmcnt(4)
    buffer_load_dwordx4 v[64:67], v1, s[40:43], s8 offen offset:3072 nt
    v_add_f32_dpp v22, v20, v20 row_shl:8 row_mask:0xf bank_mask:0x3
    v_add_f32_dpp v22, v21, v21 row_shr:8 row_mask:0xf bank_mask:0xc
    v_mov_b32 v20, 0
    v_dot2c_f32_bf16 v20, v72, v36
    v_dot2c_f32_bf16 v20, v73, v37
    v_dot2c_f32_bf16 v20, v74, v38
    v_dot2c_f32_bf16 v20, v75, v39
    v_mov_b32 v21, 0
    v_dot2c_f32_bf16 v21, v76, v36
    v_dot2c_f32_bf16 v21, v77, v37
    v_dot2c_f32_bf16 v21, v78, v38
    v_dot2c_f32_bf16 v21, v79, v39
    v_add_f32_dpp v23, v20, v20 row_shl:8 row_mask:0xf bank_mask:0x3
    s_nop 1
    v_add_f32_dpp v23, v21, v21 row_shr:8 row_mask:0xf bank_mask:0xc
    v_add_f32_dpp v24, v22, v22 row_shl:4 row_mask:0xf bank_mask:0x5
    s_nop 0
    v_add_f32_dpp v24, v23, v23 row_shr:4 row_mask:0xf bank_mask:0xa
    s_nop 1
    v_add_f32_dpp v24, v24, v24 quad_perm:[2,3,0,1] row_mask:0xf bank_mask:0xf
    v_mov_b32 v20, 0
    v_dot2c_f32_bf16 v20, v80, v36
    v_dot2c_f32_bf16 v20, v81, v37
    v_dot2c_f32_bf16 v20, v82, v38
    v_dot2c_f32_bf16 v20, v83, v39
    s_waitcnt vmcnt(4)
    s_mov_b32 s8, 540672
    buffer_load_dwordx4 v[68:71], v1, s[40:43], s8 offen offset:0 nt
    v_mov_b32 v21, 0
    v_dot2c_f32_bf16 v21, v84, v36
    v_dot2c_f32_bf16 v21, v85, v37
    v_dot2c_f32_bf16 v21, v86, v38
    v_dot2c_f32_bf16 v21, v87, v39
    v_add_f32_dpp v22, v20, v20 row_shl:8 row_mask:0xf bank_mask:0x3
    s_nop 1
    v_add_f32_dpp v22, v21, v21 row_shr:8 row_mask:0xf bank_mask:0xc
    v_mov_b32 v20, 0
    v_dot2c_f32_bf16 v20, v88, v36
    v_dot2c_f32_bf16 v20, v89, v37
    v_dot2c_f32_bf16 v20, v90, v38
    v_dot2c_f32_bf16 v20, v91, v39
    v_mov_b32 v21, 0
    v_dot2c_f32_bf16 v21, v92, v36
    v_dot2c_f32_bf16 v21, v93, v37
    v_dot2c_f32_bf16 v21, v94, v38
    v_dot2c_f32_bf16 v21, v95, v39
    s_waitcnt vmcnt(4)
    buffer_load_dwordx4 v[72:75], v1, s[40:43], s8 offen offset:1024 nt
    v_add_f32_dpp v23, v20, v20 row_shl:8 row_mask:0xf bank_mask:0x3
    v_add_f32_dpp v23, v21, v21 row_shr:8 row_mask:0xf bank_mask:0xc
    v_add_f32_dpp v25, v22, v22 row_shl:4 row_mask:0xf bank_mask:0x5
    s_nop 0
    v_add_f32_dpp v25, v23, v23 row_shr:4 row_mask:0xf bank_mask:0xa
    s_nop 1
    v_add_f32_dpp v25, v25, v25 quad_perm:[2,3,0,1] row_mask:0xf bank_mask:0xf
    v_cndmask_b32 v26, v24, v25, s[86:87]
    s_nop 1
    v_add_f32_dpp v26, v26, v26 quad_perm:[1,0,3,2] row_mask:0xf bank_mask:0xf
    v_mov_b32 v20, 0
    v_dot2c_f32_bf16 v20, v96, v36
    v_dot2c_f32_bf16 v20, v97, v37
    v_dot2c_f32_bf16 v20, v98, v38
    v_dot2c_f32_bf16 v20, v99, v39
    v_mov_b32 v21, 0
    v_dot2c_f32_bf16 v21, v100, v36
    v_dot2c_f32_bf16 v21, v101, v37
    v_dot2c_f32_bf16 v21, v102, v38
    v_dot2c_f32_bf16 v21, v103, v39
    v_add_f32_dpp v22, v20, v20 row_shl:8 row_mask:0xf bank_mask:0x3
    s_nop 1
    v_add_f32_dpp v22, v21, v21 row_shr:8 row_mask:0xf bank_mask:0xc
    v_mov_b32 v20, 0
    v_dot2c_f32_bf16 v20, v104, v36
    v_dot2c_f32_bf16 v20, v105, v37
    v_dot2c_f32_bf16 v20, v106, v38
    v_dot2c_f32_bf16 v20, v107, v39
    s_waitcnt vmcnt(4)
    buffer_load_dwordx4 v[76:79], v1, s[40:43], s8 offen offset:2048 nt
    v_mov_b32 v21, 0
    v_dot2c_f32_bf16 v21, v108, v36
    v_dot2c_f32_bf16 v21, v109, v37
    v_dot2c_f32_bf16 v21, v110, v38
    v_dot2c_f32_bf16 v21, v111, v39
    v_add_f32_dpp v23, v20, v20 row_shl:8 row_mask:0xf bank_mask:0x3
    s_nop 1
    v_add_f32_dpp v23, v21, v21 row_shr:8 row_mask:0xf bank_mask:0xc
    v_add_f32_dpp v24, v22, v22 row_shl:4 row_mask:0xf bank_mask:0x5
    s_nop 0
    v_add_f32_dpp v24, v23, v23 row_shr:4 row_mask:0xf bank_mask:0xa
    s_nop 1
    v_add_f32_dpp v24, v24, v24 quad_perm:[2,3,0,1] row_mask:0xf bank_mask:0xf
    v_mov_b32 v20, 0
    v_dot2c_f32_bf16 v20, v112, v36
    v_dot2c_f32_bf16 v20, v113, v37
    v_dot2c_f32_bf16 v20, v114, v38
    v_dot2c_f32_bf16 v20, v115, v39
    v_mov_b32 v21, 0
    v_dot2c_f32_bf16 v21, v116, v36
    v_dot2c_f32_bf16 v21, v117, v37
    v_dot2c_f32_bf16 v21, v118, v38
    v_dot2c_f32_bf16 v21, v119, v39
    s_waitcnt vmcnt(4)
    buffer_load_dwordx4 v[80:83], v1, s[40:43], s8 offen offset:3072 nt
    v_add_f32_dpp v22, v20, v20 row_shl:8 row_mask:0xf bank_mask:0x3
    v_add_f32_dpp v22, v21, v21 row_shr:8 row_mask:0xf bank_mask:0xc
    v_mov_b32 v20, 0
    v_dot2c_f32_bf16 v20, v120, v36
    v_dot2c_f32_bf16 v20, v121, v37
    v_dot2c_f32_bf16 v20, v122, v38
    v_dot2c_f32_bf16 v20, v123, v39
    v_mov_b32 v21, 0
    v_dot2c_f32_bf16 v21, v124, v36
    v_dot2c_f32_bf16 v21, v125, v37
    v_dot2c_f32_bf16 v21, v126, v38
    v_dot2c_f32_bf16 v21, v127, v39
    v_add_f32_dpp v23, v20, v20 row_shl:8 row_mask:0xf bank_mask:0x3
    s_nop 1
    v_add_f32_dpp v23, v21, v21 row_shr:8 row_mask:0xf bank_mask:0xc
    v_add_f32_dpp v25, v22, v22 row_shl:4 row_mask:0xf bank_mask:0x5
    s_nop 0
    v_add_f32_dpp v25, v23, v23 row_shr:4 row_mask:0xf bank_mask:0xa
    s_nop 1
    v_add_f32_dpp v25, v25, v25 quad_perm:[2,3,0,1] row_mask:0xf bank_mask:0xf
    v_cndmask_b32 v27, v24, v25, s[86:87]
    s_nop 1
    v_add_f32_dpp v27, v27, v27 quad_perm:[1,0,3,2] row_mask:0xf bank_mask:0xf
    v_cndmask_b32 v47, v26, v27, s[88:89]
    v_mov_b32 v20, 0
    v_dot2c_f32_bf16 v20, v128, v36
    v_dot2c_f32_bf16 v20, v129, v37
    v_dot2c_f32_bf16 v20, v130, v38
    v_dot2c_f32_bf16 v20, v131, v39
    s_waitcnt vmcnt(4)
    s_mov_b32 s8, 589824
    buffer_load_dwordx4 v[84:87], v1, s[40:43], s8 offen offset:0 nt
    v_mov_b32 v21, 0
    v_dot2c_f32_bf16 v21, v132, v36
    v_dot2c_f32_bf16 v21, v133, v37
    v_dot2c_f32_bf16 v21, v134, v38
    v_dot2c_f32_bf16 v21, v135, v39
    v_add_f32_dpp v22, v20, v20 row_shl:8 row_mask:0xf bank_mask:0x3
    s_nop 1
    v_add_f32_dpp v22, v21, v21 row_shr:8 row_mask:0xf bank_mask:0xc
    v_mov_b32 v20, 0
    v_dot2c_f32_bf16 v20, v136, v36
    v_dot2c_f32_bf16 v20, v137, v37
    v_dot2c_f32_bf16 v20, v138, v38
    v_dot2c_f32_bf16 v20, v139, v39
    v_mov_b32 v21, 0
    v_dot2c_f32_bf16 v21, v64, v36
    v_dot2c_f32_bf16 v21, v65, v37
    v_dot2c_f32_bf16 v21, v66, v38
    v_dot2c_f32_bf16 v21, v67, v39
    s_waitcnt vmcnt(4)
    buffer_load_dwordx4 v[64:67], v1, s[40:43], s8 offen offset:1024 nt
    v_add_f32_dpp v23, v20, v20 row_shl:8 row_mask:0xf bank_mask:0x3
    v_add_f32_dpp v23, v21, v21 row_shr:8 row_mask:0xf bank_mask:0xc
    v_add_f32_dpp v24, v22, v22 row_shl:4 row_mask:0xf bank_mask:0x5
    s_nop 0
    v_add_f32_dpp v24, v23, v23 row_shr:4 row_mask:0xf bank_mask:0xa
    s_nop 1
    v_add_f32_dpp v24, v24, v24 quad_perm:[2,3,0,1] row_mask:0xf bank_mask:0xf
    v_mov_b32 v20, 0
    v_dot2c_f32_bf16 v20, v68, v36
    v_dot2c_f32_bf16 v20, v69, v37
    v_dot2c_f32_bf16 v20, v70, v38
    v_dot2c_f32_bf16 v20, v71, v39
    v_mov_b32 v21, 0
    s_waitcnt vmcnt(4)
    v_dot2c_f32_bf16 v21, v72, v36
    v_dot2c_f32_bf16 v21, v73, v37
    v_dot2c_f32_bf16 v21, v74, v38
    v_dot2c_f32_bf16 v21, v75, v39
    buffer_load_dwordx4 v[68:71], v1, s[40:43], s8 offen offset:2048 nt
    v_add_f32_dpp v22, v20, v20 row_shl:8 row_mask:0xf bank_mask:0x3
    s_nop 0
    v_add_f32_dpp v22, v21, v21 row_shr:8 row_mask:0xf bank_mask:0xc
    v_mov_b32 v20, 0
    s_waitcnt vmcnt(4)
    v_dot2c_f32_bf16 v20, v76, v36
    v_dot2c_f32_bf16 v20, v77, v37
    v_dot2c_f32_bf16 v20, v78, v38
    v_dot2c_f32_bf16 v20, v79, v39
    buffer_load_dwordx4 v[72:75], v1, s[40:43], s8 offen offset:3072 nt
    v_mov_b32 v21, 0
    s_waitcnt vmcnt(4)
    v_dot2c_f32_bf16 v21, v80, v36
    v_dot2c_f32_bf16 v21, v81, v37
    v_dot2c_f32_bf16 v21, v82, v38
    v_dot2c_f32_bf16 v21, v83, v39
    s_mov_b32 s8, 606208
    buffer_load_dwordx4 v[76:79], v1, s[40:43], s8 offen offset:0 nt
    v_add_f32_dpp v23, v20, v20 row_shl:8 row_mask:0xf bank_mask:0x3
    v_add_f32_dpp v23, v21, v21 row_shr:8 row_mask:0xf bank_mask:0xc
    v_add_f32_dpp v25, v22, v22 row_shl:4 row_mask:0xf bank_mask:0x5
    s_nop 0
    v_add_f32_dpp v25, v23, v23 row_shr:4 row_mask:0xf bank_mask:0xa
    s_nop 1
    v_add_f32_dpp v25, v25, v25 quad_perm:[2,3,0,1] row_mask:0xf bank_mask:0xf
    v_cndmask_b32 v26, v24, v25, s[86:87]
    s_nop 1
    v_add_f32_dpp v26, v26, v26 quad_perm:[1,0,3,2] row_mask:0xf bank_mask:0xf
    v_mov_b32 v20, 0
    s_waitcnt vmcnt(4)
    v_dot2c_f32_bf16 v20, v84, v36
    v_dot2c_f32_bf16 v20, v85, v37
    v_dot2c_f32_bf16 v20, v86, v38
    v_dot2c_f32_bf16 v20, v87, v39
    buffer_load_dwordx4 v[80:83], v1, s[40:43], s8 offen offset:1024 nt
    v_mov_b32 v21, 0
    s_waitcnt vmcnt(4)
    v_dot2c_f32_bf16 v21, v64, v36
    v_dot2c_f32_bf16 v21, v65, v37
    v_dot2c_f32_bf16 v21, v66, v38
    v_dot2c_f32_bf16 v21, v67, v39
    buffer_load_dwordx4 v[64:67], v1, s[40:43], s8 offen offset:2048 nt
    v_add_f32_dpp v22, v20, v20 row_shl:8 row_mask:0xf bank_mask:0x3
    s_nop 0
    v_add_f32_dpp v22, v21, v21 row_shr:8 row_mask:0xf bank_mask:0xc
    v_mov_b32 v20, 0
    s_waitcnt vmcnt(4)
    v_dot2c_f32_bf16 v20, v68, v36
    v_dot2c_f32_bf16 v20, v69, v37
    v_dot2c_f32_bf16 v20, v70, v38
    v_dot2c_f32_bf16 v20, v71, v39
    buffer_load_dwordx4 v[68:71], v1, s[40:43], s8 offen offset:3072 nt
    v_mov_b32 v21, 0
    s_waitcnt vmcnt(4)
    v_dot2c_f32_bf16 v21, v72, v36
    v_dot2c_f32_bf16 v21, v73, v37
    v_dot2c_f32_bf16 v21, v74, v38
    v_dot2c_f32_bf16 v21, v75, v39
    s_mov_b32 s8, 655360
    buffer_load_dwordx4 v[72:75], v1, s[40:43], s8 offen offset:0 nt
    v_add_f32_dpp v23, v20, v20 row_shl:8 row_mask:0xf bank_mask:0x3
    v_add_f32_dpp v23, v21, v21 row_shr:8 row_mask:0xf bank_mask:0xc
    v_add_f32_dpp v24, v22, v22 row_shl:4 row_mask:0xf bank_mask:0x5
    s_nop 0
    v_add_f32_dpp v24, v23, v23 row_shr:4 row_mask:0xf bank_mask:0xa
    s_nop 1
    v_add_f32_dpp v24, v24, v24 quad_perm:[2,3,0,1] row_mask:0xf bank_mask:0xf
    v_mov_b32 v20, 0
    s_waitcnt vmcnt(4)
    v_dot2c_f32_bf16 v20, v76, v36
    v_dot2c_f32_bf16 v20, v77, v37
    v_dot2c_f32_bf16 v20, v78, v38
    v_dot2c_f32_bf16 v20, v79, v39
    buffer_load_dwordx4 v[76:79], v1, s[40:43], s8 offen offset:1024 nt
    v_mov_b32 v21, 0
    s_waitcnt vmcnt(4)
    v_dot2c_f32_bf16 v21, v80, v36
    v_dot2c_f32_bf16 v21, v81, v37
    v_dot2c_f32_bf16 v21, v82, v38
    v_dot2c_f32_bf16 v21, v83, v39
    buffer_load_dwordx4 v[80:83], v1, s[40:43], s8 offen offset:2048 nt
    v_add_f32_dpp v22, v20, v20 row_shl:8 row_mask:0xf bank_mask:0x3
    s_nop 0
    v_add_f32_dpp v22, v21, v21 row_shr:8 row_mask:0xf bank_mask:0xc
    v_mov_b32 v20, 0
    s_waitcnt vmcnt(4)
    v_dot2c_f32_bf16 v20, v64, v36
    v_dot2c_f32_bf16 v20, v65, v37
    v_dot2c_f32_bf16 v20, v66, v38
    v_dot2c_f32_bf16 v20, v67, v39
    buffer_load_dwordx4 v[64:67], v1, s[40:43], s8 offen offset:3072 nt
    v_mov_b32 v21, 0
    s_waitcnt vmcnt(4)
    v_dot2c_f32_bf16 v21, v68, v36
    v_dot2c_f32_bf16 v21, v69, v37
    v_dot2c_f32_bf16 v21, v70, v38
    v_dot2c_f32_bf16 v21, v71, v39
    s_mov_b32 s8, 671744
    buffer_load_dwordx4 v[68:71], v1, s[40:43], s8 offen offset:0 nt
    v_add_f32_dpp v23, v20, v20 row_shl:8 row_mask:0xf bank_mask:0x3
    v_add_f32_dpp v23, v21, v21 row_shr:8 row_mask:0xf bank_mask:0xc
    v_add_f32_dpp v25, v22, v22 row_shl:4 row_mask:0xf bank_mask:0x5
    s_nop 0
    v_add_f32_dpp v25, v23, v23 row_shr:4 row_mask:0xf bank_mask:0xa
    s_nop 1
    v_add_f32_dpp v25, v25, v25 quad_perm:[2,3,0,1] row_mask:0xf bank_mask:0xf
    v_cndmask_b32 v27, v24, v25, s[86:87]
    s_nop 1
    v_add_f32_dpp v27, v27, v27 quad_perm:[1,0,3,2] row_mask:0xf bank_mask:0xf
    v_cndmask_b32 v48, v26, v27, s[88:89]
    v_mov_b32 v20, 0
    s_waitcnt vmcnt(4)
    v_dot2c_f32_bf16 v20, v72, v36
    v_dot2c_f32_bf16 v20, v73, v37
    v_dot2c_f32_bf16 v20, v74, v38
    v_dot2c_f32_bf16 v20, v75, v39
    buffer_load_dwordx4 v[72:75], v1, s[40:43], s8 offen offset:1024 nt
    v_mov_b32 v21, 0
    s_waitcnt vmcnt(4)
    v_dot2c_f32_bf16 v21, v76, v36
    v_dot2c_f32_bf16 v21, v77, v37
    v_dot2c_f32_bf16 v21, v78, v38
    v_dot2c_f32_bf16 v21, v79, v39
    buffer_load_dwordx4 v[76:79], v1, s[40:43], s8 offen offset:2048 nt
    v_add_f32_dpp v22, v20, v20 row_shl:8 row_mask:0xf bank_mask:0x3
    s_nop 0
    v_add_f32_dpp v22, v21, v21 row_shr:8 row_mask:0xf bank_mask:0xc
    v_mov_b32 v20, 0
    s_waitcnt vmcnt(4)
    v_dot2c_f32_bf16 v20, v80, v36
    v_dot2c_f32_bf16 v20, v81, v37
    v_dot2c_f32_bf16 v20, v82, v38
    v_dot2c_f32_bf16 v20, v83, v39
    buffer_load_dwordx4 v[80:83], v1, s[40:43], s8 offen offset:3072 nt
    v_mov_b32 v21, 0
    s_waitcnt vmcnt(4)
    v_dot2c_f32_bf16 v21, v64, v36
    v_dot2c_f32_bf16 v21, v65, v37
    v_dot2c_f32_bf16 v21, v66, v38
    v_dot2c_f32_bf16 v21, v67, v39
    s_memrealtime s[84:85]
    s_mov_b32 s8, 720896
    buffer_load_dwordx4 v[64:67], v1, s[40:43], s8 offen offset:0 nt
    v_add_f32_dpp v23, v20, v20 row_shl:8 row_mask:0xf bank_mask:0x3
    v_add_f32_dpp v23, v21, v21 row_shr:8 row_mask:0xf bank_mask:0xc
    v_add_f32_dpp v24, v22, v22 row_shl:4 row_mask:0xf bank_mask:0x5
    s_nop 0
    v_add_f32_dpp v24, v23, v23 row_shr:4 row_mask:0xf bank_mask:0xa
    s_nop 1
    v_add_f32_dpp v24, v24, v24 quad_perm:[2,3,0,1] row_mask:0xf bank_mask:0xf
    v_mov_b32 v20, 0
    s_waitcnt vmcnt(4)
    v_dot2c_f32_bf16 v20, v68, v36
    v_dot2c_f32_bf16 v20, v69, v37
    v_dot2c_f32_bf16 v20, v70, v38
    v_dot2c_f32_bf16 v20, v71, v39
    s_waitcnt lgkmcnt(0)
    s_cmp_eq_u32 s15, 0
    s_cbranch_scc0 L_cp3
    v_mov_b32 v30, s84
    v_mov_b32 v31, s90
    s_add_u32 s9, s83, 0
    s_mov_b64 exec, 1
    buffer_store_dwordx2 v[30:31], v8, s[76:79], s9 offen
    s_mov_b64 exec, -1
L_cp3:
    buffer_load_dwordx4 v[68:71], v1, s[40:43], s8 offen offset:1024 nt
    v_mov_b32 v21, 0
    s_waitcnt vmcnt(4)
    v_dot2c_f32_bf16 v21, v72, v36
    v_dot2c_f32_bf16 v21, v73, v37
    v_dot2c_f32_bf16 v21, v74, v38
    v_dot2c_f32_bf16 v21, v75, v39
    buffer_load_dwordx4 v[72:75], v1, s[40:43], s8 offen offset:2048 nt
    v_add_f32_dpp v22, v20, v20 row_shl:8 row_mask:0xf bank_mask:0x3
    s_nop 0
    v_add_f32_dpp v22, v21, v21 row_shr:8 row_mask:0xf bank_mask:0xc
    v_mov_b32 v20, 0
    s_waitcnt vmcnt(4)
    v_dot2c_f32_bf16 v20, v76, v36
    v_dot2c_f32_bf16 v20, v77, v37
    v_dot2c_f32_bf16 v20, v78, v38
    v_dot2c_f32_bf16 v20, v79, v39
    buffer_load_dwordx4 v[76:79], v1, s[40:43], s8 offen offset:3072 nt
    v_mov_b32 v21, 0
    s_waitcnt vmcnt(4)
    v_dot2c_f32_bf16 v21, v80, v36
    v_dot2c_f32_bf16 v21, v81, v37
    v_dot2c_f32_bf16 v21, v82, v38
    v_dot2c_f32_bf16 v21, v83, v39
    s_mov_b32 s8, 737280
    buffer_load_dwordx4 v[80:83], v1, s[40:43], s8 offen offset:0 nt
    v_add_f32_dpp v23, v20, v20 row_shl:8 row_mask:0xf bank_mask:0x3
    v_add_f32_dpp v23, v21, v21 row_shr:8 row_mask:0xf bank_mask:0xc
    v_add_f32_dpp v25, v22, v22 row_shl:4 row_mask:0xf bank_mask:0x5
    s_nop 0
    v_add_f32_dpp v25, v23, v23 row_shr:4 row_mask:0xf bank_mask:0xa
    s_nop 1
    v_add_f32_dpp v25, v25, v25 quad_perm:[2,3,0,1] row_mask:0xf bank_mask:0xf
    v_cndmask_b32 v26, v24, v25, s[86:87]
    s_nop 1
    v_add_f32_dpp v26, v26, v26 quad_perm:[1,0,3,2] row_mask:0xf bank_mask:0xf
    v_mov_b32 v20, 0
    s_waitcnt vmcnt(4)
    v_dot2c_f32_bf16 v20, v64, v36
    v_dot2c_f32_bf16 v20, v65, v37
    v_dot2c_f32_bf16 v20, v66, v38
    v_dot2c_f32_bf16 v20, v67, v39
    buffer_load_dwordx4 v[64:67], v1, s[40:43], s8 offen offset:1024 nt
    v_mov_b32 v21, 0
    s_waitcnt vmcnt(4)
    v_dot2c_f32_bf16 v21, v68, v36
    v_dot2c_f32_bf16 v21, v69, v37
    v_dot2c_f32_bf16 v21, v70, v38
    v_dot2c_f32_bf16 v21, v71, v39
    buffer_load_dwordx4 v[68:71], v1, s[40:43], s8 offen offset:2048 nt
    v_add_f32_dpp v22, v20, v20 row_shl:8 row_mask:0xf bank_mask:0x3
    s_nop 0
    v_add_f32_dpp v22, v21, v21 row_shr:8 row_mask:0xf bank_mask:0xc
    v_mov_b32 v20, 0
    s_waitcnt vmcnt(4)
    v_dot2c_f32_bf16 v20, v72, v36
    v_dot2c_f32_bf16 v20, v73, v37
    v_dot2c_f32_bf16 v20, v74, v38
    v_dot2c_f32_bf16 v20, v75, v39
    buffer_load_dwordx4 v[72:75], v1, s[40:43], s8 offen offset:3072 nt
    v_mov_b32 v21, 0
    s_waitcnt vmcnt(4)
    v_dot2c_f32_bf16 v21, v76, v36
    v_dot2c_f32_bf16 v21, v77, v37
    v_dot2c_f32_bf16 v21, v78, v38
    v_dot2c_f32_bf16 v21, v79, v39
    s_mov_b32 s8, 786432
    buffer_load_dwordx4 v[76:79], v1, s[40:43], s8 offen offset:0 nt
    v_add_f32_dpp v23, v20, v20 row_shl:8 row_mask:0xf bank_mask:0x3
    v_add_f32_dpp v23, v21, v21 row_shr:8 row_mask:0xf bank_mask:0xc
    v_add_f32_dpp v24, v22, v22 row_shl:4 row_mask:0xf bank_mask:0x5
    s_nop 0
    v_add_f32_dpp v24, v23, v23 row_shr:4 row_mask:0xf bank_mask:0xa
    s_nop 1
    v_add_f32_dpp v24, v24, v24 quad_perm:[2,3,0,1] row_mask:0xf bank_mask:0xf
    v_mov_b32 v20, 0
    s_waitcnt vmcnt(4)
    v_dot2c_f32_bf16 v20, v80, v36
    v_dot2c_f32_bf16 v20, v81, v37
    v_dot2c_f32_bf16 v20, v82, v38
    v_dot2c_f32_bf16 v20, v83, v39
    buffer_load_dwordx4 v[80:83], v1, s[40:43], s8 offen offset:1024 nt
    v_mov_b32 v21, 0
    s_waitcnt vmcnt(4)
    v_dot2c_f32_bf16 v21, v64, v36
    v_dot2c_f32_bf16 v21, v65, v37
    v_dot2c_f32_bf16 v21, v66, v38
    v_dot2c_f32_bf16 v21, v67, v39
    buffer_load_dwordx4 v[64:67], v1, s[40:43], s8 offen offset:2048 nt
    v_add_f32_dpp v22, v20, v20 row_shl:8 row_mask:0xf bank_mask:0x3
    s_nop 0
    v_add_f32_dpp v22, v21, v21 row_shr:8 row_mask:0xf bank_mask:0xc
    v_mov_b32 v20, 0
    s_waitcnt vmcnt(4)
    v_dot2c_f32_bf16 v20, v68, v36
    v_dot2c_f32_bf16 v20, v69, v37
    v_dot2c_f32_bf16 v20, v70, v38
    v_dot2c_f32_bf16 v20, v71, v39
    buffer_load_dwordx4 v[68:71], v1, s[40:43], s8 offen offset:3072 nt
    v_mov_b32 v21, 0
    s_waitcnt vmcnt(4)
    v_dot2c_f32_bf16 v21, v72, v36
    v_dot2c_f32_bf16 v21, v73, v37
    v_dot2c_f32_bf16 v21, v74, v38
    v_dot2c_f32_bf16 v21, v75, v39
    s_add_u32 s9, s82, 0
    buffer_load_dwordx2 v[32:33], v34, s[76:79], s9 offen sc1
    s_mov_b32 s8, 802816
    buffer_load_dwordx4 v[72:75], v1, s[40:43], s8 offen offset:0 nt
    v_add_f32_dpp v23, v20, v20 row_shl:8 row_mask:0xf bank_mask:0x3
    v_add_f32_dpp v23, v21, v21 row_shr:8 row_mask:0xf bank_mask:0xc
    v_add_f32_dpp v25, v22, v22 row_shl:4 row_mask:0xf bank_mask:0x5
    s_nop 0
    v_add_f32_dpp v25, v23, v23 row_shr:4 row_mask:0xf bank_mask:0xa
    s_nop 1
    v_add_f32_dpp v25, v25, v25 quad_perm:[2,3,0,1] row_mask:0xf bank_mask:0xf
    v_cndmask_b32 v27, v24, v25, s[86:87]
    s_nop 1
    v_add_f32_dpp v27, v27, v27 quad_perm:[1,0,3,2] row_mask:0xf bank_mask:0xf
    v_cndmask_b32 v49, v26, v27, s[88:89]
    v_mov_b32 v20, 0
    s_waitcnt vmcnt(5)
    v_dot2c_f32_bf16 v20, v76, v36
    v_dot2c_f32_bf16 v20, v77, v37
    v_dot2c_f32_bf16 v20, v78, v38
    v_dot2c_f32_bf16 v20, v79, v39
    buffer_load_dwordx4 v[76:79], v1, s[40:43], s8 offen offset:1024 nt
    v_mov_b32 v21, 0
    s_waitcnt vmcnt(5)
    v_dot2c_f32_bf16 v21, v80, v36
    v_dot2c_f32_bf16 v21, v81, v37
    v_dot2c_f32_bf16 v21, v82, v38
    v_dot2c_f32_bf16 v21, v83, v39
    buffer_load_dwordx4 v[80:83], v1, s[40:43], s8 offen offset:2048 nt
    v_add_f32_dpp v22, v20, v20 row_shl:8 row_mask:0xf bank_mask:0x3
    s_nop 0
    v_add_f32_dpp v22, v21, v21 row_shr:8 row_mask:0xf bank_mask:0xc
    v_mov_b32 v20, 0
    s_waitcnt vmcnt(5)
    v_dot2c_f32_bf16 v20, v64, v36
    v_dot2c_f32_bf16 v20, v65, v37
    v_dot2c_f32_bf16 v20, v66, v38
    v_dot2c_f32_bf16 v20, v67, v39
    buffer_load_dwordx4 v[64:67], v1, s[40:43], s8 offen offset:3072 nt
    v_mov_b32 v21, 0
    s_waitcnt vmcnt(5)
    v_dot2c_f32_bf16 v21, v68, v36
    v_dot2c_f32_bf16 v21, v69, v37
    v_dot2c_f32_bf16 v21, v70, v38
    v_dot2c_f32_bf16 v21, v71, v39
    s_mov_b32 s8, 851968
    buffer_load_dwordx4 v[68:71], v1, s[40:43], s8 offen offset:0 nt
    v_add_f32_dpp v23, v20, v20 row_shl:8 row_mask:0xf bank_mask:0x3
    v_add_f32_dpp v23, v21, v21 row_shr:8 row_mask:0xf bank_mask:0xc
    v_add_f32_dpp v24, v22, v22 row_shl:4 row_mask:0xf bank_mask:0x5
    s_nop 0
    v_add_f32_dpp v24, v23, v23 row_shr:4 row_mask:0xf bank_mask:0xa
    s_nop 1
    v_add_f32_dpp v24, v24, v24 quad_perm:[2,3,0,1] row_mask:0xf bank_mask:0xf
    v_mov_b32 v20, 0
    s_waitcnt vmcnt(4)
    v_dot2c_f32_bf16 v20, v72, v36
    v_dot2c_f32_bf16 v20, v73, v37
    v_dot2c_f32_bf16 v20, v74, v38
    v_dot2c_f32_bf16 v20, v75, v39
    buffer_load_dwordx4 v[72:75], v1, s[40:43], s8 offen offset:1024 nt
    v_mov_b32 v21, 0
    s_waitcnt vmcnt(4)
    v_dot2c_f32_bf16 v21, v76, v36
    v_dot2c_f32_bf16 v21, v77, v37
    v_dot2c_f32_bf16 v21, v78, v38
    v_dot2c_f32_bf16 v21, v79, v39
    buffer_load_dwordx4 v[76:79], v1, s[40:43], s8 offen offset:2048 nt
    v_add_f32_dpp v22, v20, v20 row_shl:8 row_mask:0xf bank_mask:0x3
    s_nop 0
    v_add_f32_dpp v22, v21, v21 row_shr:8 row_mask:0xf bank_mask:0xc
    v_mov_b32 v20, 0
    s_waitcnt vmcnt(4)
    v_dot2c_f32_bf16 v20, v80, v36
    v_dot2c_f32_bf16 v20, v81, v37
    v_dot2c_f32_bf16 v20, v82, v38
    v_dot2c_f32_bf16 v20, v83, v39
    buffer_load_dwordx4 v[80:83], v1, s[40:43], s8 offen offset:3072 nt
    v_cmp_eq_u32 vcc, s90, v33
    v_sub_u32 v32, s84, v32
    v_cvt_f32_i32 v32, v32
    v_mov_b32 v33, 0xc3480000
    v_cndmask_b32 v32, v33, v32, vcc
    s_nop 1
    v_add_f32_dpp v32, v32, v32 row_ror:8 row_mask:0xf bank_mask:0xf
    s_nop 1
    v_add_f32_dpp v32, v32, v32 row_ror:4 row_mask:0xf bank_mask:0xf
    s_nop 1
    v_add_f32_dpp v32, v32, v32 row_ror:2 row_mask:0xf bank_mask:0xf
    s_nop 1
    v_add_f32_dpp v32, v32, v32 row_ror:1 row_mask:0xf bank_mask:0xf
    s_nop 1
    v_add_f32_dpp v32, v32, v32 row_bcast:15 row_mask:0xa bank_mask:0xf
    s_nop 1
    v_add_f32_dpp v32, v32, v32 row_bcast:31 row_mask:0xc bank_mask:0xf
    s_nop 0
    v_readlane_b32 s9, v32, 63
    v_mov_b32 v33, 0x3a8f5c29
    s_nop 0
    v_mul_f32 v32, s9, v33
    v_cvt_i32_f32 v32, v32
    v_med3_i32 v32, v32, -8, 8
    s_nop 0
    v_readfirstlane_b32 s81, v32
    s_nop 0
    s_cmp_gt_i32 s81, 0
    s_cselect_b32 s80, 1, 0
    s_cmp_lt_i32 s81, 0
    s_cselect_b32 s9, 1, 0
    s_sub_u32 s81, s81, s80
    s_add_u32 s81, s81, s9
    s_lshl1_add_u32 s80, s9, s80
    s_cmp_eq_u32 s80, 1
    s_cbranch_scc1 L_bw4
    s_waitcnt vmcnt(4)
    s_cmp_eq_u32 s80, 0
    s_cbranch_scc1 L_bw4
    s_waitcnt vmcnt(3)
L_bw4:
    s_mov_b32 s8, 868352
    buffer_load_dwordx4 v[84:87], v1, s[40:43], s8 offen offset:0 nt
    v_mov_b32 v21, 0
    s_waitcnt vmcnt(5)
    v_dot2c_f32_bf16 v21, v64, v36
    v_dot2c_f32_bf16 v21, v65, v37
    v_dot2c_f32_bf16 v21, v66, v38
    v_dot2c_f32_bf16 v21, v67, v39
    s_cmp_eq_u32 s80, 1
    s_cbranch_scc1 L_bw5
    s_waitcnt vmcnt(4)
    s_cmp_eq_u32 s80, 0
    s_cbranch_scc1 L_bw5
    s_waitcnt vmcnt(3)
L_bw5:
    buffer_load_dwordx4 v[64:67], v1, s[40:43], s8 offen offset:1024 nt
    s_cmp_eq_u32 s80, 1
    s_cbranch_scc1 L_bw6
    s_waitcnt vmcnt(4)
    s_cmp_eq_u32 s80, 0
    s_cbranch_scc1 L_bw6
    s_waitcnt vmcnt(3)
L_bw6:
    buffer_load_dwordx4 v[88:91], v1, s[40:43], s8 offen offset:2048 nt
    v_add_f32_dpp v23, v20, v20 row_shl:8 row_mask:0xf bank_mask:0x3
    v_add_f32_dpp v23, v21, v21 row_shr:8 row_mask:0xf bank_mask:0xc
    v_add_f32_dpp v25, v22, v22 row_shl:4 row_mask:0xf bank_mask:0x5
    s_nop 0
    v_add_f32_dpp v25, v23, v23 row_shr:4 row_mask:0xf bank_mask:0xa
    s_nop 1
    v_add_f32_dpp v25, v25, v25 quad_perm:[2,3,0,1] row_mask:0xf bank_mask:0xf
    v_cndmask_b32 v26, v24, v25, s[86:87]
    s_nop 1
    v_add_f32_dpp v26, v26, v26 quad_perm:[1,0,3,2] row_mask:0xf bank_mask:0xf
    v_mov_b32 v20, 0
    s_waitcnt vmcnt(6)
    v_dot2c_f32_bf16 v20, v68, v36
    v_dot2c_f32_bf16 v20, v69, v37
    v_dot2c_f32_bf16 v20, v70, v38
    v_dot2c_f32_bf16 v20, v71, v39
    s_cmp_eq_u32 s80, 1
    s_cbranch_scc1 L_bw7
    s_waitcnt vmcnt(4)
    s_cmp_eq_u32 s80, 0
    s_cbranch_scc1 L_bw7
    s_waitcnt vmcnt(3)
L_bw7:
    buffer_load_dwordx4 v[68:71], v1, s[40:43], s8 offen offset:3072 nt
    v_mov_b32 v21, 0
    s_waitcnt vmcnt(6)
    v_dot2c_f32_bf16 v21, v72, v36
    v_dot2c_f32_bf16 v21, v73, v37
    v_dot2c_f32_bf16 v21, v74, v38
    v_dot2c_f32_bf16 v21, v75, v39
    s_cmp_gt_i32 s81, 0
    s_cselect_b32 s80, 1, 0
    s_cmp_lt_i32 s81, 0
    s_cselect_b32 s9, 1, 0
    s_sub_u32 s81, s81, s80
    s_add_u32 s81, s81, s9
    s_lshl1_add_u32 s80, s9, s80
    s_cmp_eq_u32 s80, 1
    s_cbranch_scc1 L_bw8
    s_waitcnt vmcnt(4)
    s_cmp_eq_u32 s80, 0
    s_cbranch_scc1 L_bw8
    s_waitcnt vmcnt(3)
L_bw8:
    s_mov_b32 s8, 917504
    buffer_load_dwordx4 v[72:75], v1, s[40:43], s8 offen offset:0 nt
    v_add_f32_dpp v22, v20, v20 row_shl:8 row_mask:0xf bank_mask:0x3
    v_add_f32_dpp v22, v21, v21 row_shr:8 row_mask:0xf bank_mask:0xc
    v_mov_b32 v20, 0
    s_waitcnt vmcnt(6)
    v_dot2c_f32_bf16 v20, v76, v36
    v_dot2c_f32_bf16 v20, v77, v37
    v_dot2c_f32_bf16 v20, v78, v38
    v_dot2c_f32_bf16 v20, v79, v39
    s_cmp_eq_u32 s80, 1
    s_cbranch_scc1 L_bw9
    s_waitcnt vmcnt(4)
    s_cmp_eq_u32 s80, 0
    s_cbranch_scc1 L_bw9
    s_waitcnt vmcnt(3)
L_bw9:
    buffer_load_dwordx4 v[76:79], v1, s[40:43], s8 offen offset:1024 nt
    v_mov_b32 v21, 0
    s_waitcnt vmcnt(6)
    v_dot2c_f32_bf16 v21, v80, v36
    v_dot2c_f32_bf16 v21, v81, v37
    v_dot2c_f32_bf16 v21, v82, v38
    v_dot2c_f32_bf16 v21, v83, v39
    s_cmp_eq_u32 s80, 1
    s_cbranch_scc1 L_bw10
    s_waitcnt vmcnt(4)
    s_cmp_eq_u32 s80, 0
    s_cbranch_scc1 L_bw10
    s_waitcnt vmcnt(3)
L_bw10:
    buffer_load_dwordx4 v[80:83], v1, s[40:43], s8 offen offset:2048 nt
    v_add_f32_dpp v23, v20, v20 row_shl:8 row_mask:0xf bank_mask:0x3
    v_add_f32_dpp v23, v21, v21 row_shr:8 row_mask:0xf bank_mask:0xc
    v_add_f32_dpp v24, v22, v22 row_shl:4 row_mask:0xf bank_mask:0x5
    s_nop 0
    v_add_f32_dpp v24, v23, v23 row_shr:4 row_mask:0xf bank_mask:0xa
    s_nop 1
    v_add_f32_dpp v24, v24, v24 quad_perm:[2,3,0,1] row_mask:0xf bank_mask:0xf
    v_mov_b32 v20, 0
    s_waitcnt vmcnt(6)
    v_dot2c_f32_bf16 v20, v84, v36
    v_dot2c_f32_bf16 v20, v85, v37
    v_dot2c_f32_bf16 v20, v86, v38
    v_dot2c_f32_bf16 v20, v87, v39
    s_cmp_eq_u32 s80, 1
    s_cbranch_scc1 L_bw11
    s_waitcnt vmcnt(4)
    s_cmp_eq_u32 s80, 0
    s_cbranch_scc1 L_bw11
    s_waitcnt vmcnt(3)
L_bw11:
    buffer_load_dwordx4 v[84:87], v1, s[40:43], s8 offen offset:3072 nt
    v_mov_b32 v21, 0
    s_waitcnt vmcnt(6)
    v_dot2c_f32_bf16 v21, v64, v36
    v_dot2c_f32_bf16 v21, v65, v37
    v_dot2c_f32_bf16 v21, v66, v38
    v_dot2c_f32_bf16 v21, v67, v39
    s_cmp_gt_i32 s81, 0
    s_cselect_b32 s80, 1, 0
    s_cmp_lt_i32 s81, 0
    s_cselect_b32 s9, 1, 0
    s_sub_u32 s81, s81, s80
    s_add_u32 s81, s81, s9
    s_lshl1_add_u32 s80, s9, s80
    s_cmp_eq_u32 s80, 1
    s_cbranch_scc1 L_bw12
    s_waitcnt vmcnt(4)
    s_cmp_eq_u32 s80, 0
    s_cbranch_scc1 L_bw12
    s_waitcnt vmcnt(3)
L_bw12:
    s_mov_b32 s8, 933888
    buffer_load_dwordx4 v[64:67], v1, s[40:43], s8 offen offset:0 nt
    v_add_f32_dpp v22, v20, v20 row_shl:8 row_mask:0xf bank_mask:0x3
    v_add_f32_dpp v22, v21, v21 row_shr:8 row_mask:0xf bank_mask:0xc
    v_mov_b32 v20, 0
    s_waitcnt vmcnt(6)
    v_dot2c_f32_bf16 v20, v88, v36
    v_dot2c_f32_bf16 v20, v89, v37
    v_dot2c_f32_bf16 v20, v90, v38
    v_dot2c_f32_bf16 v20, v91, v39
    s_cmp_eq_u32 s80, 1
    s_cbranch_scc1 L_bw13
    s_waitcnt vmcnt(4)
    s_cmp_eq_u32 s80, 0
    s_cbranch_scc1 L_bw13
    s_waitcnt vmcnt(3)
L_bw13:
    buffer_load_dwordx4 v[88:91], v1, s[40:43], s8 offen offset:1024 nt
    v_mov_b32 v21, 0
    s_waitcnt vmcnt(6)
    v_dot2c_f32_bf16 v21, v68, v36
    v_dot2c_f32_bf16 v21, v69, v37
    v_dot2c_f32_bf16 v21, v70, v38
    v_dot2c_f32_bf16 v21, v71, v39
    s_cmp_eq_u32 s80, 1
    s_cbranch_scc1 L_bw14
    s_waitcnt vmcnt(4)
    s_cmp_eq_u32 s80, 0
    s_cbranch_scc1 L_bw14
    s_waitcnt vmcnt(3)
L_bw14:
    buffer_load_dwordx4 v[68:71], v1, s[40:43], s8 offen offset:2048 nt
    v_add_f32_dpp v23, v20, v20 row_shl:8 row_mask:0xf bank_mask:0x3
    v_add_f32_dpp v23, v21, v21 row_shr:8 row_mask:0xf bank_mask:0xc
    v_add_f32_dpp v25, v22, v22 row_shl:4 row_mask:0xf bank_mask:0x5
    s_nop 0
    v_add_f32_dpp v25, v23, v23 row_shr:4 row_mask:0xf bank_mask:0xa
    s_nop 1
    v_add_f32_dpp v25, v25, v25 quad_perm:[2,3,0,1] row_mask:0xf bank_mask:0xf
    v_cndmask_b32 v27, v24, v25, s[86:87]
    s_nop 1
    v_add_f32_dpp v27, v27, v27 quad_perm:[1,0,3,2] row_mask:0xf bank_mask:0xf
    v_cndmask_b32 v50, v26, v27, s[88:89]
    v_mov_b32 v20, 0
    s_waitcnt vmcnt(6)
    v_dot2c_f32_bf16 v20, v72, v36
    v_dot2c_f32_bf16 v20, v73, v37
    v_dot2c_f32_bf16 v20, v74, v38
    v_dot2c_f32_bf16 v20, v75, v39
    s_cmp_eq_u32 s80, 1
    s_cbranch_scc1 L_bw15
    s_waitcnt vmcnt(4)
    s_cmp_eq_u32 s80, 0
    s_cbranch_scc1 L_bw15
    s_waitcnt vmcnt(3)
L_bw15:
    buffer_load_dwordx4 v[72:75], v1, s[40:43], s8 offen offset:3072 nt
    v_mov_b32 v21, 0
    s_waitcnt vmcnt(6)
    v_dot2c_f32_bf16 v21, v76, v36
    v_dot2c_f32_bf16 v21, v77, v37
    v_dot2c_f32_bf16 v21, v78, v38
    v_dot2c_f32_bf16 v21, v79, v39
    s_cmp_gt_i32 s81, 0
    s_cselect_b32 s80, 1, 0
    s_cmp_lt_i32 s81, 0
    s_cselect_b32 s9, 1, 0
    s_sub_u32 s81, s81, s80
    s_add_u32 s81, s81, s9
    s_lshl1_add_u32 s80, s9, s80
    s_cmp_eq_u32 s80, 1
    s_cbranch_scc1 L_bw16
    s_waitcnt vmcnt(4)
    s_cmp_eq_u32 s80, 0
    s_cbranch_scc1 L_bw16
    s_waitcnt vmcnt(3)
L_bw16:
    s_mov_b32 s8, 983040
    buffer_load_dwordx4 v[76:79], v1, s[40:43], s8 offen offset:0 nt
    v_add_f32_dpp v22, v20, v20 row_shl:8 row_mask:0xf bank_mask:0x3
    v_add_f32_dpp v22, v21, v21 row_shr:8 row_mask:0xf bank_mask:0xc
    v_mov_b32 v20, 0
    s_waitcnt vmcnt(6)
    v_dot2c_f32_bf16 v20, v80, v36
    v_dot2c_f32_bf16 v20, v81, v37
    v_dot2c_f32_bf16 v20, v82, v38
    v_dot2c_f32_bf16 v20, v83, v39
    s_cmp_eq_u32 s80, 1
    s_cbranch_scc1 L_bw17
    s_waitcnt vmcnt(4)
    s_cmp_eq_u32 s80, 0
    s_cbranch_scc1 L_bw17
    s_waitcnt vmcnt(3)
L_bw17:
    buffer_load_dwordx4 v[80:83], v1, s[40:43], s8 offen offset:1024 nt
    v_mov_b32 v21, 0
    s_waitcnt vmcnt(6)
    v_dot2c_f32_bf16 v21, v84, v36
    v_dot2c_f32_bf16 v21, v85, v37
    v_dot2c_f32_bf16 v21, v86, v38
    v_dot2c_f32_bf16 v21, v87, v39
    s_cmp_eq_u32 s80, 1
    s_cbranch_scc1 L_bw18
    s_waitcnt vmcnt(4)
    s_cmp_eq_u32 s80, 0
    s_cbranch_scc1 L_bw18
    s_waitcnt vmcnt(3)
L_bw18:
    buffer_load_dwordx4 v[84:87], v1, s[40:43], s8 offen offset:2048 nt
    v_add_f32_dpp v23, v20, v20 row_shl:8 row_mask:0xf bank_mask:0x3
    v_add_f32_dpp v23, v21, v21 row_shr:8 row_mask:0xf bank_mask:0xc
    v_add_f32_dpp v24, v22, v22 row_shl:4 row_mask:0xf bank_mask:0x5
    s_nop 0
    v_add_f32_dpp v24, v23, v23 row_shr:4 row_mask:0xf bank_mask:0xa
    s_nop 1
    v_add_f32_dpp v24, v24, v24 quad_perm:[2,3,0,1] row_mask:0xf bank_mask:0xf
    v_mov_b32 v20, 0
    s_waitcnt vmcnt(6)
    v_dot2c_f32_bf16 v20, v64, v36
    v_dot2c_f32_bf16 v20, v65, v37
    v_dot2c_f32_bf16 v20, v66, v38
    v_dot2c_f32_bf16 v20, v67, v39
    s_cmp_eq_u32 s80, 1
    s_cbranch_scc1 L_bw19
    s_waitcnt vmcnt(4)
    s_cmp_eq_u32 s80, 0
    s_cbranch_scc1 L_bw19
    s_waitcnt vmcnt(3)
L_bw19:
    buffer_load_dwordx4 v[64:67], v1, s[40:43], s8 offen offset:3072 nt
    v_mov_b32 v21, 0
    s_waitcnt vmcnt(6)
    v_dot2c_f32_bf16 v21, v88, v36
    v_dot2c_f32_bf16 v21, v89, v37
    v_dot2c_f32_bf16 v21, v90, v38
    v_dot2c_f32_bf16 v21, v91, v39
    s_cmp_gt_i32 s81, 0
    s_cselect_b32 s80, 1, 0
    s_cmp_lt_i32 s81, 0
    s_cselect_b32 s9, 1, 0
    s_sub_u32 s81, s81, s80
    s_add_u32 s81, s81, s9
    s_lshl1_add_u32 s80, s9, s80
    s_cmp_eq_u32 s80, 1
    s_cbranch_scc1 L_bw20
    s_waitcnt vmcnt(4)
    s_cmp_eq_u32 s80, 0
    s_cbranch_scc1 L_bw20
    s_waitcnt vmcnt(3)
L_bw20:
    s_mov_b32 s8, 999424
    buffer_load_dwordx4 v[88:91], v1, s[40:43], s8 offen offset:0 nt
    v_add_f32_dpp v22, v20, v20 row_shl:8 row_mask:0xf bank_mask:0x3
    v_add_f32_dpp v22, v21, v21 row_shr:8 row_mask:0xf bank_mask:0xc
    v_mov_b32 v20, 0
    s_waitcnt vmcnt(6)
    v_dot2c_f32_bf16 v20, v68, v36
    v_dot2c_f32_bf16 v20, v69, v37
    v_dot2c_f32_bf16 v20, v70, v38
    v_dot2c_f32_bf16 v20, v71, v39
    s_cmp_eq_u32 s80, 1
    s_cbranch_scc1 L_bw21
    s_waitcnt vmcnt(4)
    s_cmp_eq_u32 s80, 0
    s_cbranch_scc1 L_bw21
    s_waitcnt vmcnt(3)
L_bw21:
    buffer_load_dwordx4 v[68:71], v1, s[40:43], s8 offen offset:1024 nt
    v_mov_b32 v21, 0
    s_waitcnt vmcnt(6)
    v_dot2c_f32_bf16 v21, v72, v36
    v_dot2c_f32_bf16 v21, v73, v37
    v_dot2c_f32_bf16 v21, v74, v38
    v_dot2c_f32_bf16 v21, v75, v39
    s_cmp_eq_u32 s80, 1
    s_cbranch_scc1 L_bw22
    s_waitcnt vmcnt(4)
    s_cmp_eq_u32 s80, 0
    s_cbranch_scc1 L_bw22
    s_waitcnt vmcnt(3)
L_bw22:
    buffer_load_dwordx4 v[72:75], v1, s[40:43], s8 offen offset:2048 nt
    v_add_f32_dpp v23, v20, v20 row_shl:8 row_mask:0xf bank_mask:0x3
    v_add_f32_dpp v23, v21, v21 row_shr:8 row_mask:0xf bank_mask:0xc
    v_add_f32_dpp v25, v22, v22 row_shl:4 row_mask:0xf bank_mask:0x5
    s_nop 0
    v_add_f32_dpp v25, v23, v23 row_shr:4 row_mask:0xf bank_mask:0xa
    s_nop 1
    v_add_f32_dpp v25, v25, v25 quad_perm:[2,3,0,1] row_mask:0xf bank_mask:0xf
    v_cndmask_b32 v26, v24, v25, s[86:87]
    s_nop 1
    v_add_f32_dpp v26, v26, v26 quad_perm:[1,0,3,2] row_mask:0xf bank_mask:0xf
    v_mov_b32 v20, 0
    s_waitcnt vmcnt(6)
    v_dot2c_f32_bf16 v20, v76, v36
    v_dot2c_f32_bf16 v20, v77, v37
    v_dot2c_f32_bf16 v20, v78, v38
    v_dot2c_f32_bf16 v20, v79, v39
    s_cmp_eq_u32 s80, 1
    s_cbranch_scc1 L_bw23
    s_waitcnt vmcnt(4)
    s_cmp_eq_u32 s80, 0
    s_cbranch_scc1 L_bw23
    s_waitcnt vmcnt(3)
L_bw23:
    buffer_load_dwordx4 v[76:79], v1, s[40:43], s8 offen offset:3072 nt
    v_mov_b32 v21, 0
    s_waitcnt vmcnt(6)
    v_dot2c_f32_bf16 v21, v80, v36
    v_dot2c_f32_bf16 v21, v81, v37
    v_dot2c_f32_bf16 v21, v82, v38
    v_dot2c_f32_bf16 v21, v83, v39
    s_cmp_gt_i32 s81, 0
    s_cselect_b32 s80, 1, 0
    s_cmp_lt_i32 s81, 0
    s_cselect_b32 s9, 1, 0
    s_sub_u32 s81, s81, s80
    s_add_u32 s81, s81, s9
    s_lshl1_add_u32 s80, s9, s80
    s_cmp_eq_u32 s80, 1
    s_cbranch_scc1 L_bw24
    s_waitcnt vmcnt(4)
    s_cmp_eq_u32 s80, 0
    s_cbranch_scc1 L_bw24
    s_waitcnt vmcnt(3)
L_bw24:
    buffer_load_dwordx4 v[80:83], v1, s[44:47], 0 offen offset:0 nt
    v_add_f32_dpp v22, v20, v20 row_shl:8 row_mask:0xf bank_mask:0x3
    v_add_f32_dpp v22, v21, v21 row_shr:8 row_mask:0xf bank_mask:0xc
    v_mov_b32 v20, 0
    s_waitcnt vmcnt(6)
    v_dot2c_f32_bf16 v20, v84, v36
    v_dot2c_f32_bf16 v20, v85, v37
    v_dot2c_f32_bf16 v20, v86, v38
    v_dot2c_f32_bf16 v20, v87, v39
    s_cmp_eq_u32 s80, 1
    s_cbranch_scc1 L_bw25
    s_waitcnt vmcnt(4)
    s_cmp_eq_u32 s80, 0
    s_cbranch_scc1 L_bw25
    s_waitcnt vmcnt(3)
L_bw25:
    buffer_load_dwordx4 v[84:87], v1, s[44:47], 0 offen offset:1024 nt
    v_mov_b32 v21, 0
    s_waitcnt vmcnt(6)
    v_dot2c_f32_bf16 v21, v64, v36
    v_dot2c_f32_bf16 v21, v65, v37
    v_dot2c_f32_bf16 v21, v66, v38
    v_dot2c_f32_bf16 v21, v67, v39
    s_cmp_eq_u32 s80, 1
    s_cbranch_scc1 L_bw26
    s_waitcnt vmcnt(4)
    s_cmp_eq_u32 s80, 0
    s_cbranch_scc1 L_bw26
    s_waitcnt vmcnt(3)
L_bw26:
    buffer_load_dwordx4 v[64:67], v1, s[44:47], 0 offen offset:2048 nt
    v_add_f32_dpp v23, v20, v20 row_shl:8 row_mask:0xf bank_mask:0x3
    v_add_f32_dpp v23, v21, v21 row_shr:8 row_mask:0xf bank_mask:0xc
    v_add_f32_dpp v24, v22, v22 row_shl:4 row_mask:0xf bank_mask:0x5
    s_nop 0
    v_add_f32_dpp v24, v23, v23 row_shr:4 row_mask:0xf bank_mask:0xa
    s_nop 1
    v_add_f32_dpp v24, v24, v24 quad_perm:[2,3,0,1] row_mask:0xf bank_mask:0xf
    v_mov_b32 v20, 0
    s_waitcnt vmcnt(6)
    v_dot2c_f32_bf16 v20, v88, v36
    v_dot2c_f32_bf16 v20, v89, v37
    v_dot2c_f32_bf16 v20, v90, v38
    v_dot2c_f32_bf16 v20, v91, v39
    s_cmp_eq_u32 s80, 1
    s_cbranch_scc1 L_bw27
    s_waitcnt vmcnt(4)
    s_cmp_eq_u32 s80, 0
    s_cbranch_scc1 L_bw27
    s_waitcnt vmcnt(3)
L_bw27:
    buffer_load_dwordx4 v[88:91], v1, s[44:47], 0 offen offset:3072 nt
    v_mov_b32 v21, 0
    s_waitcnt vmcnt(6)
    v_dot2c_f32_bf16 v21, v68, v36
    v_dot2c_f32_bf16 v21, v69, v37
    v_dot2c_f32_bf16 v21, v70, v38
    v_dot2c_f32_bf16 v21, v71, v39
    s_cmp_gt_i32 s81, 0
    s_cselect_b32 s80, 1, 0
    s_cmp_lt_i32 s81, 0
    s_cselect_b32 s9, 1, 0
    s_sub_u32 s81, s81, s80
    s_add_u32 s81, s81, s9
    s_lshl1_add_u32 s80, s9, s80
    s_cmp_eq_u32 s80, 1
    s_cbranch_scc1 L_bw28
    s_waitcnt vmcnt(4)
    s_cmp_eq_u32 s80, 0
    s_cbranch_scc1 L_bw28
    s_waitcnt vmcnt(3)
L_bw28:
    s_mov_b32 s8, 16384
    buffer_load_dwordx4 v[68:71], v1, s[44:47], s8 offen offset:0 nt
    v_add_f32_dpp v22, v20, v20 row_shl:8 row_mask:0xf bank_mask:0x3
    v_add_f32_dpp v22, v21, v21 row_shr:8 row_mask:0xf bank_mask:0xc
    v_mov_b32 v20, 0
    s_waitcnt vmcnt(6)
    v_dot2c_f32_bf16 v20, v72, v36
    v_dot2c_f32_bf16 v20, v73, v37
    v_dot2c_f32_bf16 v20, v74, v38
    v_dot2c_f32_bf16 v20, v75, v39
    s_cmp_eq_u32 s80, 1
    s_cbranch_scc1 L_bw29
    s_waitcnt vmcnt(4)
    s_cmp_eq_u32 s80, 0
    s_cbranch_scc1 L_bw29
    s_waitcnt vmcnt(3)
L_bw29:
    buffer_load_dwordx4 v[72:75], v1, s[44:47], s8 offen offset:1024 nt
    v_mov_b32 v21, 0
    s_waitcnt vmcnt(6)
    v_dot2c_f32_bf16 v21, v76, v36
    v_dot2c_f32_bf16 v21, v77, v37
    v_dot2c_f32_bf16 v21, v78, v38
    v_dot2c_f32_bf16 v21, v79, v39
    s_cmp_eq_u32 s80, 1
    s_cbranch_scc1 L_bw30
    s_waitcnt vmcnt(4)
    s_cmp_eq_u32 s80, 0
    s_cbranch_scc1 L_bw30
    s_waitcnt vmcnt(3)
L_bw30:
    buffer_load_dwordx4 v[76:79], v1, s[44:47], s8 offen offset:2048 nt
    v_add_f32_dpp v23, v20, v20 row_shl:8 row_mask:0xf bank_mask:0x3
    v_add_f32_dpp v23, v21, v21 row_shr:8 row_mask:0xf bank_mask:0xc
    v_add_f32_dpp v25, v22, v22 row_shl:4 row_mask:0xf bank_mask:0x5
    s_nop 0
    v_add_f32_dpp v25, v23, v23 row_shr:4 row_mask:0xf bank_mask:0xa
    s_nop 1
    v_add_f32_dpp v25, v25, v25 quad_perm:[2,3,0,1] row_mask:0xf bank_mask:0xf
    v_cndmask_b32 v27, v24, v25, s[86:87]
    s_nop 1
    v_add_f32_dpp v27, v27, v27 quad_perm:[1,0,3,2] row_mask:0xf bank_mask:0xf
    v_cndmask_b32 v51, v26, v27, s[88:89]
    v_cvt_pk_bf16_f32 v20, v44, v45
    v_cvt_pk_bf16_f32 v22, v46, v47
    v_cvt_pk_bf16_f32 v24, v48, v49
    v_cvt_pk_bf16_f32 v26, v50, v51
    v_lshlrev_b32 v44, 16, v20
    v_and_b32 v45, 0xffff0000, v20
    v_lshlrev_b32 v46, 16, v22
    v_and_b32 v47, 0xffff0000, v22
    v_lshlrev_b32 v48, 16, v24
    v_and_b32 v49, 0xffff0000, v24
    v_lshlrev_b32 v50, 16, v26
    v_and_b32 v51, 0xffff0000, v26
    v_mul_f32 v44, 0x3db504f3, v44
    v_mul_f32 v45, 0x3db504f3, v45
    v_mul_f32 v46, 0x3db504f3, v46
    v_mul_f32 v47, 0x3db504f3, v47
    v_mul_f32 v48, 0x3db504f3, v48
    v_mul_f32 v49, 0x3db504f3, v49
    v_mul_f32 v50, 0x3db504f3, v50
    v_mul_f32 v51, 0x3db504f3, v51
    v_cvt_pk_bf16_f32 v20, v44, v45
    v_cvt_pk_bf16_f32 v22, v46, v47
    v_cvt_pk_bf16_f32 v24, v48, v49
    v_cvt_pk_bf16_f32 v26, v50, v51
    v_lshlrev_b32 v44, 16, v20
    v_and_b32 v45, 0xffff0000, v20
    v_lshlrev_b32 v46, 16, v22
    v_and_b32 v47, 0xffff0000, v22
    v_lshlrev_b32 v48, 16, v24
    v_and_b32 v49, 0xffff0000, v24
    v_lshlrev_b32 v50, 16, v26
    v_and_b32 v51, 0xffff0000, v26
    v_max3_f32 v20, v44, v45, v46
    v_max3_f32 v21, v47, v48, v49
    v_max3_f32 v20, v20, v50, v51
    v_max_f32 v20, v20, v21
    s_nop 1
    v_max_f32_dpp v20, v20, v20 row_ror:8 row_mask:0xf bank_mask:0xf
    s_nop 1
    v_max_f32_dpp v20, v20, v20 row_ror:4 row_mask:0xf bank_mask:0xf
    s_nop 1
    v_max_f32_dpp v20, v20, v20 row_ror:2 row_mask:0xf bank_mask:0xf
    s_nop 1
    v_max_f32_dpp v20, v20, v20 row_ror:1 row_mask:0xf bank_mask:0xf
    s_waitcnt vmcnt(6)
    s_cmp_eq_u32 s80, 1
    s_cbranch_scc1 L_bw31
    s_waitcnt vmcnt(4)
    s_cmp_eq_u32 s80, 0
    s_cbranch_scc1 L_bw31
    s_waitcnt vmcnt(3)
L_bw31:
    buffer_load_dwordx4 v[92:95], v1, s[44:47], s8 offen offset:3072 nt
    v_max_f32_dpp v20, v20, v20 row_bcast:15 row_mask:0xa bank_mask:0xf
    s_nop 1
    v_max_f32_dpp v20, v20, v20 row_bcast:31 row_mask:0xc bank_mask:0xf
    s_nop 0
    v_readlane_b32 s12, v20, 63
    s_nop 1
    v_subrev_f32 v44, s12, v44
    v_subrev_f32 v45, s12, v45
    v_subrev_f32 v46, s12, v46
    v_subrev_f32 v47, s12, v47
    v_subrev_f32 v48, s12, v48
    v_subrev_f32 v49, s12, v49
    v_subrev_f32 v50, s12, v50
    v_subrev_f32 v51, s12, v51
    v_mul_f32 v44, s91, v44
    v_mul_f32 v45, s91, v45
    v_mul_f32 v46, s91, v46
    v_mul_f32 v47, s91, v47
    v_mul_f32 v48, s91, v48
    v_mul_f32 v49, s91, v49
    v_mul_f32 v50, s91, v50
    v_mul_f32 v51, s91, v51
    v_exp_f32 v44, v44
    v_exp_f32 v45, v45
    v_exp_f32 v46, v46
    v_exp_f32 v47, v47
    v_exp_f32 v48, v48
    v_exp_f32 v49, v49
    v_exp_f32 v50, v50
    v_exp_f32 v51, v51
    v_add_f32 v20, v44, v45
    v_add_f32 v21, v46, v47
    v_add_f32 v22, v48, v49
    v_add_f32 v23, v50, v51
    v_add_f32 v20, v20, v21
    v_add_f32 v22, v22, v23
    v_cvt_pk_bf16_f32 v44, v44, v44
    v_cvt_pk_bf16_f32 v45, v45, v45
    v_cvt_pk_bf16_f32 v46, v46, v46
    v_cvt_pk_bf16_f32 v47, v47, v47
    v_cvt_pk_bf16_f32 v48, v48, v48
    v_cvt_pk_bf16_f32 v49, v49, v49
    v_cvt_pk_bf16_f32 v50, v50, v50
    v_cvt_pk_bf16_f32 v51, v51, v51
    v_add_f32 v20, v20, v22
    s_nop 1
    v_add_f32_dpp v20, v20, v20 row_ror:8 row_mask:0xf bank_mask:0xf
    s_nop 1
    v_add_f32_dpp v20, v20, v20 row_ror:4 row_mask:0xf bank_mask:0xf
    s_nop 1
    v_add_f32_dpp v20, v20, v20 row_ror:2 row_mask:0xf bank_mask:0xf
    s_nop 1
    v_add_f32_dpp v20, v20, v20 row_ror:1 row_mask:0xf bank_mask:0xf
    s_cmp_gt_i32 s81, 0
    s_cselect_b32 s80, 1, 0
    s_cmp_lt_i32 s81, 0
    s_cselect_b32 s9, 1, 0
    s_sub_u32 s81, s81, s80
    s_add_u32 s81, s81, s9
    s_lshl1_add_u32 s80, s9, s80
    s_waitcnt vmcnt(6)
    s_cmp_eq_u32 s80, 1
    s_cbranch_scc1 L_bw32
    s_waitcnt vmcnt(4)
    s_cmp_eq_u32 s80, 0
    s_cbranch_scc1 L_bw32
    s_waitcnt vmcnt(3)
L_bw32:
    s_mov_b32 s8, 65536
    buffer_load_dwordx4 v[96:99], v1, s[44:47], s8 offen offset:0 nt
    v_add_f32_dpp v20, v20, v20 row_bcast:15 row_mask:0xa bank_mask:0xf
    s_nop 1
    v_add_f32_dpp v20, v20, v20 row_bcast:31 row_mask:0xc bank_mask:0xf
    s_nop 0
    v_readlane_b32 s13, v20, 63
    v_mov_b32 v22, s12
    s_nop 0
    v_mov_b32 v23, s13
    s_lshl_b32 s9, s15, 3
    v_mov_b32 v25, s9
    v_mov_b32 v26, 1
    s_mov_b64 exec, 1
    ds_write_b64 v25, v[22:23] offset:26880
    ds_add_u32 v8, v26 offset:27468
    s_mov_b64 exec, -1
    v_mov_b32_dpp v15, v44 row_newbcast:0 row_mask:0xf bank_mask:0xf
    v_and_b32 v12, v15, v2
    v_and_b32 v13, v15, v3
    v_and_b32 v14, v15, v4
    v_and_b32 v15, v15, v5
    v_mov_b32_dpp v19, v44 row_newbcast:8 row_mask:0xf bank_mask:0xf
    v_and_b32 v16, v19, v2
    v_and_b32 v17, v19, v3
    v_and_b32 v18, v19, v4
    v_and_b32 v19, v19, v5
    v_mfma_f32_16x16x32_bf16 v[40:43], v[80:83], v[12:15], 0
    v_mov_b32_dpp v15, v44 row_newbcast:4 row_mask:0xf bank_mask:0xf
    v_and_b32 v12, v15, v2
    v_and_b32 v13, v15, v3
    v_and_b32 v14, v15, v4
    v_and_b32 v15, v15, v5
    v_mfma_f32_16x16x32_bf16 v[40:43], v[84:87], v[16:19], v[40:43]
    v_mov_b32_dpp v19, v44 row_newbcast:12 row_mask:0xf bank_mask:0xf
    v_and_b32 v16, v19, v2
    v_and_b32 v17, v19, v3
    v_and_b32 v18, v19, v4
    v_and_b32 v19, v19, v5
    s_waitcnt vmcnt(6)
    v_mfma_f32_16x16x32_bf16 v[40:43], v[64:67], v[12:15], v[40:43]
    s_cmp_eq_u32 s80, 1
    s_cbranch_scc1 L_bw33
    s_waitcnt vmcnt(4)
    s_cmp_eq_u32 s80, 0
    s_cbranch_scc1 L_bw33
    s_waitcnt vmcnt(3)
L_bw33:
    buffer_load_dwordx4 v[64:67], v1, s[44:47], s8 offen offset:1024 nt
    v_mov_b32_dpp v15, v44 row_newbcast:2 row_mask:0xf bank_mask:0xf
    v_and_b32 v12, v15, v2
    v_and_b32 v13, v15, v3
    v_and_b32 v14, v15, v4
    v_and_b32 v15, v15, v5
    s_waitcnt vmcnt(6)
    v_mfma_f32_16x16x32_bf16 v[40:43], v[88:91], v[16:19], v[40:43]
    s_cmp_eq_u32 s80, 1
    s_cbranch_scc1 L_bw34
    s_waitcnt vmcnt(4)
    s_cmp_eq_u32 s80, 0
    s_cbranch_scc1 L_bw34
    s_waitcnt vmcnt(3)
L_bw34:
    buffer_load_dwordx4 v[80:83], v1, s[44:47], s8 offen offset:2048 nt
    v_mov_b32_dpp v19, v44 row_newbcast:10 row_mask:0xf bank_mask:0xf
    v_and_b32 v16, v19, v2
    v_and_b32 v17, v19, v3
    v_and_b32 v18, v19, v4
    v_and_b32 v19, v19, v5
    s_waitcnt vmcnt(6)
    v_mfma_f32_16x16x32_bf16 v[40:43], v[68:71], v[12:15], v[40:43]
    s_cmp_eq_u32 s80, 1
    s_cbranch_scc1 L_bw35
    s_waitcnt vmcnt(4)
    s_cmp_eq_u32 s80, 0
    s_cbranch_scc1 L_bw35
    s_waitcnt vmcnt(3)
L_bw35:
    buffer_load_dwordx4 v[68:71], v1, s[44:47], s8 offen offset:3072 nt
    v_mov_b32_dpp v15, v44 row_newbcast:6 row_mask:0xf bank_mask:0xf
    v_and_b32 v12, v15, v2
    v_and_b32 v13, v15, v3
    v_and_b32 v14, v15, v4
    v_and_b32 v15, v15, v5
    s_waitcnt vmcnt(6)
    v_mfma_f32_16x16x32_bf16 v[40:43], v[72:75], v[16:19], v[40:43]
    s_memrealtime s[84:85]
    s_cmp_gt_i32 s81, 0
    s_cselect_b32 s80, 1, 0
    s_cmp_lt_i32 s81, 0
    s_cselect_b32 s9, 1, 0
    s_sub_u32 s81, s81, s80
    s_add_u32 s81, s81, s9
    s_lshl1_add_u32 s80, s9, s80
    s_cmp_eq_u32 s80, 1
    s_cbranch_scc1 L_bw36
    s_waitcnt vmcnt(4)
    s_cmp_eq_u32 s80, 0
    s_cbranch_scc1 L_bw36
    s_waitcnt vmcnt(3)
L_bw36:
    s_mov_b32 s8, 81920
    buffer_load_dwordx4 v[72:75], v1, s[44:47], s8 offen offset:0 nt
    v_mov_b32_dpp v19, v44 row_newbcast:14 row_mask:0xf bank_mask:0xf
    v_and_b32 v16, v19, v2
    v_and_b32 v17, v19, v3
    v_and_b32 v18, v19, v4
    v_and_b32 v19, v19, v5
    s_waitcnt vmcnt(6)
    v_mfma_f32_16x16x32_bf16 v[40:43], v[76:79], v[12:15], v[40:43]
    s_waitcnt lgkmcnt(0)
    s_cmp_eq_u32 s15, 0
    s_cbranch_scc0 L_cp37
    v_mov_b32 v30, s84
    v_mov_b32 v31, s90
    s_add_u32 s9, s83, 2048
    s_mov_b64 exec, 1
    buffer_store_dwordx2 v[30:31], v8, s[76:79], s9 offen
    s_mov_b64 exec, -1
L_cp37:
    s_cmp_eq_u32 s80, 1
    s_cbranch_scc1 L_bw38
    s_waitcnt vmcnt(4)
    s_cmp_eq_u32 s80, 0
    s_cbranch_scc1 L_bw38
    s_waitcnt vmcnt(3)
L_bw38:
    buffer_load_dwordx4 v[76:79], v1, s[44:47], s8 offen offset:1024 nt
    v_mov_b32_dpp v15, v44 row_newbcast:1 row_mask:0xf bank_mask:0xf
    v_and_b32 v12, v15, v2
    v_and_b32 v13, v15, v3
    v_and_b32 v14, v15, v4
    v_and_b32 v15, v15, v5
    s_waitcnt vmcnt(6)
    v_mfma_f32_16x16x32_bf16 v[40:43], v[92:95], v[16:19], v[40:43]
    s_cmp_eq_u32 s80, 1
    s_cbranch_scc1 L_bw39
    s_waitcnt vmcnt(4)
    s_cmp_eq_u32 s80, 0
    s_cbranch_scc1 L_bw39
    s_waitcnt vmcnt(3)
L_bw39:
    buffer_load_dwordx4 v[84:87], v1, s[44:47], s8 offen offset:2048 nt
    v_mov_b32_dpp v19, v44 row_newbcast:9 row_mask:0xf bank_mask:0xf
    v_and_b32 v16, v19, v2
    v_and_b32 v17, v19, v3
    v_and_b32 v18, v19, v4
    v_and_b32 v19, v19, v5
    s_waitcnt vmcnt(6)
    v_mfma_f32_16x16x32_bf16 v[40:43], v[96:99], v[12:15], v[40:43]
    s_cmp_eq_u32 s80, 1
    s_cbranch_scc1 L_bw40
    s_waitcnt vmcnt(4)
    s_cmp_eq_u32 s80, 0
    s_cbranch_scc1 L_bw40
    s_waitcnt vmcnt(3)
L_bw40:
    buffer_load_dwordx4 v[88:91], v1, s[44:47], s8 offen offset:3072 nt
    v_mov_b32_dpp v15, v44 row_newbcast:5 row_mask:0xf bank_mask:0xf
    v_and_b32 v12, v15, v2
    v_and_b32 v13, v15, v3
    v_and_b32 v14, v15, v4
    v_and_b32 v15, v15, v5
    s_waitcnt vmcnt(6)
    v_mfma_f32_16x16x32_bf16 v[40:43], v[64:67], v[16:19], v[40:43]
    s_cmp_gt_i32 s81, 0
    s_cselect_b32 s80, 1, 0
    s_cmp_lt_i32 s81, 0
    s_cselect_b32 s9, 1, 0
    s_sub_u32 s81, s81, s80
    s_add_u32 s81, s81, s9
    s_lshl1_add_u32 s80, s9, s80
    s_cmp_eq_u32 s80, 1
    s_cbranch_scc1 L_bw41
    s_waitcnt vmcnt(4)
    s_cmp_eq_u32 s80, 0
    s_cbranch_scc1 L_bw41
    s_waitcnt vmcnt(3)
L_bw41:
    s_mov_b32 s8, 131072
    buffer_load_dwordx4 v[64:67], v1, s[44:47], s8 offen offset:0 nt
    v_mov_b32_dpp v19, v44 row_newbcast:13 row_mask:0xf bank_mask:0xf
    v_and_b32 v16, v19, v2
    v_and_b32 v17, v19, v3
    v_and_b32 v18, v19, v4
    v_and_b32 v19, v19, v5
    s_waitcnt vmcnt(6)
    v_mfma_f32_16x16x32_bf16 v[40:43], v[80:83], v[12:15], v[40:43]
    s_cmp_eq_u32 s80, 1
    s_cbranch_scc1 L_bw42
    s_waitcnt vmcnt(4)
    s_cmp_eq_u32 s80, 0
    s_cbranch_scc1 L_bw42
    s_waitcnt vmcnt(3)
L_bw42:
    buffer_load_dwordx4 v[80:83], v1, s[44:47], s8 offen offset:1024 nt
    v_mov_b32_dpp v15, v44 row_newbcast:3 row_mask:0xf bank_mask:0xf
    v_and_b32 v12, v15, v2
    v_and_b32 v13, v15, v3
    v_and_b32 v14, v15, v4
    v_and_b32 v15, v15, v5
    s_waitcnt vmcnt(6)
    v_mfma_f32_16x16x32_bf16 v[40:43], v[68:71], v[16:19], v[40:43]
    s_cmp_eq_u32 s80, 1
    s_cbranch_scc1 L_bw43
    s_waitcnt vmcnt(4)
    s_cmp_eq_u32 s80, 0
    s_cbranch_scc1 L_bw43
    s_waitcnt vmcnt(3)
L_bw43:
    buffer_load_dwordx4 v[68:71], v1, s[44:47], s8 offen offset:2048 nt
    v_mov_b32_dpp v19, v44 row_newbcast:11 row_mask:0xf bank_mask:0xf
    v_and_b32 v16, v19, v2
    v_and_b32 v17, v19, v3
    v_and_b32 v18, v19, v4
    v_and_b32 v19, v19, v5
    s_waitcnt vmcnt(6)
    v_mfma_f32_16x16x32_bf16 v[40:43], v[72:75], v[12:15], v[40:43]
    s_cmp_eq_u32 s80, 1
    s_cbranch_scc1 L_bw44
    s_waitcnt vmcnt(4)
    s_cmp_eq_u32 s80, 0
    s_cbranch_scc1 L_bw44
    s_waitcnt vmcnt(3)
L_bw44:
    buffer_load_dwordx4 v[72:75], v1, s[44:47], s8 offen offset:3072 nt
    v_mov_b32_dpp v15, v44 row_newbcast:7 row_mask:0xf bank_mask:0xf
    v_and_b32 v12, v15, v2
    v_and_b32 v13, v15, v3
    v_and_b32 v14, v15, v4
    v_and_b32 v15, v15, v5
    s_waitcnt vmcnt(6)
    v_mfma_f32_16x16x32_bf16 v[40:43], v[76:79], v[16:19], v[40:43]
    s_cmp_gt_i32 s81, 0
    s_cselect_b32 s80, 1, 0
    s_cmp_lt_i32 s81, 0
    s_cselect_b32 s9, 1, 0
    s_sub_u32 s81, s81, s80
    s_add_u32 s81, s81, s9
    s_lshl1_add_u32 s80, s9, s80
    s_cmp_eq_u32 s80, 1
    s_cbranch_scc1 L_bw45
    s_waitcnt vmcnt(4)
    s_cmp_eq_u32 s80, 0
    s_cbranch_scc1 L_bw45
    s_waitcnt vmcnt(3)
L_bw45:
    s_mov_b32 s8, 147456
    buffer_load_dwordx4 v[76:79], v1, s[44:47], s8 offen offset:0 nt
    v_mov_b32_dpp v19, v44 row_newbcast:15 row_mask:0xf bank_mask:0xf
    v_and_b32 v16, v19, v2
    v_and_b32 v17, v19, v3
    v_and_b32 v18, v19, v4
    v_and_b32 v19, v19, v5
    s_waitcnt vmcnt(6)
    v_mfma_f32_16x16x32_bf16 v[40:43], v[84:87], v[12:15], v[40:43]
    s_cmp_eq_u32 s80, 1
    s_cbranch_scc1 L_bw46
    s_waitcnt vmcnt(4)
    s_cmp_eq_u32 s80, 0
    s_cbranch_scc1 L_bw46
    s_waitcnt vmcnt(3)
L_bw46:
    buffer_load_dwordx4 v[84:87], v1, s[44:47], s8 offen offset:1024 nt
    v_mov_b32_dpp v15, v45 row_newbcast:0 row_mask:0xf bank_mask:0xf
    v_and_b32 v12, v15, v2
    v_and_b32 v13, v15, v3
    v_and_b32 v14, v15, v4
    v_and_b32 v15, v15, v5
    s_waitcnt vmcnt(6)
    v_mfma_f32_16x16x32_bf16 v[40:43], v[88:91], v[16:19], v[40:43]
    s_cmp_eq_u32 s80, 1
    s_cbranch_scc1 L_bw47
    s_waitcnt vmcnt(4)
    s_cmp_eq_u32 s80, 0
    s_cbranch_scc1 L_bw47
    s_waitcnt vmcnt(3)
L_bw47:
    buffer_load_dwordx4 v[88:91], v1, s[44:47], s8 offen offset:2048 nt
    v_mov_b32_dpp v19, v45 row_newbcast:8 row_mask:0xf bank_mask:0xf
    v_and_b32 v16, v19, v2
    v_and_b32 v17, v19, v3
    v_and_b32 v18, v19, v4
    v_and_b32 v19, v19, v5
    s_waitcnt vmcnt(6)
    v_mfma_f32_16x16x32_bf16 v[40:43], v[64:67], v[12:15], v[40:43]
    s_cmp_eq_u32 s80, 1
    s_cbranch_scc1 L_bw48
    s_waitcnt vmcnt(4)
    s_cmp_eq_u32 s80, 0
    s_cbranch_scc1 L_bw48
    s_waitcnt vmcnt(3)
L_bw48:
    buffer_load_dwordx4 v[64:67], v1, s[44:47], s8 offen offset:3072 nt
    v_mov_b32_dpp v15, v45 row_newbcast:4 row_mask:0xf bank_mask:0xf
    v_and_b32 v12, v15, v2
    v_and_b32 v13, v15, v3
    v_and_b32 v14, v15, v4
    v_and_b32 v15, v15, v5
    s_waitcnt vmcnt(6)
    v_mfma_f32_16x16x32_bf16 v[40:43], v[80:83], v[16:19], v[40:43]
    s_add_u32 s9, s82, 2048
    buffer_load_dwordx2 v[32:33], v34, s[76:79], s9 offen sc1
    s_cmp_gt_i32 s81, 0
    s_cselect_b32 s80, 1, 0
    s_cmp_lt_i32 s81, 0
    s_cselect_b32 s9, 1, 0
    s_sub_u32 s81, s81, s80
    s_add_u32 s81, s81, s9
    s_lshl1_add_u32 s80, s9, s80
    s_cmp_eq_u32 s80, 1
    s_cbranch_scc1 L_bw49
    s_waitcnt vmcnt(5)
    s_cmp_eq_u32 s80, 0
    s_cbranch_scc1 L_bw49
    s_waitcnt vmcnt(4)
L_bw49:
    s_mov_b32 s8, 196608
    buffer_load_dwordx4 v[80:83], v1, s[44:47], s8 offen offset:0 nt
    v_mov_b32_dpp v19, v45 row_newbcast:12 row_mask:0xf bank_mask:0xf
    v_and_b32 v16, v19, v2
    v_and_b32 v17, v19, v3
    v_and_b32 v18, v19, v4
    v_and_b32 v19, v19, v5
    s_waitcnt vmcnt(7)
    v_mfma_f32_16x16x32_bf16 v[40:43], v[68:71], v[12:15], v[40:43]
    s_cmp_eq_u32 s80, 1
    s_cbranch_scc1 L_bw50
    s_waitcnt vmcnt(5)
    s_cmp_eq_u32 s80, 0
    s_cbranch_scc1 L_bw50
    s_waitcnt vmcnt(4)
L_bw50:
    buffer_load_dwordx4 v[68:71], v1, s[44:47], s8 offen offset:1024 nt
    v_mov_b32_dpp v15, v45 row_newbcast:2 row_mask:0xf bank_mask:0xf
    v_and_b32 v12, v15, v2
    v_and_b32 v13, v15, v3
    v_and_b32 v14, v15, v4
    v_and_b32 v15, v15, v5
    s_waitcnt vmcnt(7)
    v_mfma_f32_16x16x32_bf16 v[40:43], v[72:75], v[16:19], v[40:43]
    s_cmp_eq_u32 s80, 1
    s_cbranch_scc1 L_bw51
    s_waitcnt vmcnt(5)
    s_cmp_eq_u32 s80, 0
    s_cbranch_scc1 L_bw51
    s_waitcnt vmcnt(4)
L_bw51:
    buffer_load_dwordx4 v[72:75], v1, s[44:47], s8 offen offset:2048 nt
    v_mov_b32_dpp v19, v45 row_newbcast:10 row_mask:0xf bank_mask:0xf
    v_and_b32 v16, v19, v2
    v_and_b32 v17, v19, v3
    v_and_b32 v18, v19, v4
    v_and_b32 v19, v19, v5
    s_waitcnt vmcnt(7)
    v_mfma_f32_16x16x32_bf16 v[40:43], v[76:79], v[12:15], v[40:43]
    s_cmp_eq_u32 s80, 1
    s_cbranch_scc1 L_bw52
    s_waitcnt vmcnt(5)
    s_cmp_eq_u32 s80, 0
    s_cbranch_scc1 L_bw52
    s_waitcnt vmcnt(4)
L_bw52:
    buffer_load_dwordx4 v[76:79], v1, s[44:47], s8 offen offset:3072 nt
    v_mov_b32_dpp v15, v45 row_newbcast:6 row_mask:0xf bank_mask:0xf
    v_and_b32 v12, v15, v2
    v_and_b32 v13, v15, v3
    v_and_b32 v14, v15, v4
    v_and_b32 v15, v15, v5
    s_waitcnt vmcnt(7)
    v_mfma_f32_16x16x32_bf16 v[40:43], v[84:87], v[16:19], v[40:43]
    s_cmp_gt_i32 s81, 0
    s_cselect_b32 s80, 1, 0
    s_cmp_lt_i32 s81, 0
    s_cselect_b32 s9, 1, 0
    s_sub_u32 s81, s81, s80
    s_add_u32 s81, s81, s9
    s_lshl1_add_u32 s80, s9, s80
    s_cmp_eq_u32 s80, 1
    s_cbranch_scc1 L_bw53
    s_waitcnt vmcnt(5)
    s_cmp_eq_u32 s80, 0
    s_cbranch_scc1 L_bw53
    s_waitcnt vmcnt(3)
L_bw53:
    s_mov_b32 s8, 212992
    buffer_load_dwordx4 v[84:87], v1, s[44:47], s8 offen offset:0 nt
    v_mov_b32_dpp v19, v45 row_newbcast:14 row_mask:0xf bank_mask:0xf
    v_and_b32 v16, v19, v2
    v_and_b32 v17, v19, v3
    v_and_b32 v18, v19, v4
    v_and_b32 v19, v19, v5
    s_waitcnt vmcnt(7)
    v_mfma_f32_16x16x32_bf16 v[40:43], v[88:91], v[12:15], v[40:43]
    s_cmp_eq_u32 s80, 1
    s_cbranch_scc1 L_bw54
    s_waitcnt vmcnt(4)
    s_cmp_eq_u32 s80, 0
    s_cbranch_scc1 L_bw54
    s_waitcnt vmcnt(3)
L_bw54:
    buffer_load_dwordx4 v[88:91], v1, s[44:47], s8 offen offset:1024 nt
    v_mov_b32_dpp v15, v45 row_newbcast:1 row_mask:0xf bank_mask:0xf
    v_and_b32 v12, v15, v2
    v_and_b32 v13, v15, v3
    v_and_b32 v14, v15, v4
    v_and_b32 v15, v15, v5
    s_waitcnt vmcnt(7)
    v_mfma_f32_16x16x32_bf16 v[40:43], v[64:67], v[16:19], v[40:43]
    s_cmp_eq_u32 s80, 1
    s_cbranch_scc1 L_bw55
    s_waitcnt vmcnt(4)
    s_cmp_eq_u32 s80, 0
    s_cbranch_scc1 L_bw55
    s_waitcnt vmcnt(3)
L_bw55:
    buffer_load_dwordx4 v[64:67], v1, s[44:47], s8 offen offset:2048 nt
    v_mov_b32_dpp v19, v45 row_newbcast:9 row_mask:0xf bank_mask:0xf
    v_and_b32 v16, v19, v2
    v_and_b32 v17, v19, v3
    v_and_b32 v18, v19, v4
    v_and_b32 v19, v19, v5
    s_waitcnt vmcnt(6)
    v_mfma_f32_16x16x32_bf16 v[40:43], v[80:83], v[12:15], v[40:43]
    s_cmp_eq_u32 s80, 1
    s_cbranch_scc1 L_bw56
    s_waitcnt vmcnt(4)
    s_cmp_eq_u32 s80, 0
    s_cbranch_scc1 L_bw56
    s_waitcnt vmcnt(3)
L_bw56:
    buffer_load_dwordx4 v[80:83], v1, s[44:47], s8 offen offset:3072 nt
    v_mov_b32_dpp v15, v45 row_newbcast:5 row_mask:0xf bank_mask:0xf
    v_and_b32 v12, v15, v2
    v_and_b32 v13, v15, v3
    v_and_b32 v14, v15, v4
    v_and_b32 v15, v15, v5
    s_waitcnt vmcnt(6)
    v_mfma_f32_16x16x32_bf16 v[40:43], v[68:71], v[16:19], v[40:43]
    v_cmp_eq_u32 vcc, s90, v33
    v_sub_u32 v32, s84, v32
    v_cvt_f32_i32 v32, v32
    v_mov_b32 v33, 0xc3480000
    v_cndmask_b32 v32, v33, v32, vcc
    s_nop 1
    v_add_f32_dpp v32, v32, v32 row_ror:8 row_mask:0xf bank_mask:0xf
    s_nop 1
    v_add_f32_dpp v32, v32, v32 row_ror:4 row_mask:0xf bank_mask:0xf
    s_nop 1
    v_add_f32_dpp v32, v32, v32 row_ror:2 row_mask:0xf bank_mask:0xf
    s_nop 1
    v_add_f32_dpp v32, v32, v32 row_ror:1 row_mask:0xf bank_mask:0xf
    s_nop 1
    v_add_f32_dpp v32, v32, v32 row_bcast:15 row_mask:0xa bank_mask:0xf
    s_nop 1
    v_add_f32_dpp v32, v32, v32 row_bcast:31 row_mask:0xc bank_mask:0xf
    s_nop 0
    v_readlane_b32 s9, v32, 63
    v_mov_b32 v33, 0x3a8f5c29
    s_nop 0
    v_mul_f32 v32, s9, v33
    v_cvt_i32_f32 v32, v32
    v_med3_i32 v32, v32, -8, 8
    s_nop 0
    v_readfirstlane_b32 s81, v32
    s_nop 0
    s_cmp_gt_i32 s81, 0
    s_cselect_b32 s80, 1, 0
    s_cmp_lt_i32 s81, 0
    s_cselect_b32 s9, 1, 0
    s_sub_u32 s81, s81, s80
    s_add_u32 s81, s81, s9
    s_lshl1_add_u32 s80, s9, s80
    s_cmp_eq_u32 s80, 1
    s_cbranch_scc1 L_bw57
    s_waitcnt vmcnt(4)
    s_cmp_eq_u32 s80, 0
    s_cbranch_scc1 L_bw57
    s_waitcnt vmcnt(3)
L_bw57:
    s_mov_b32 s8, 262144
    buffer_load_dwordx4 v[68:71], v1, s[44:47], s8 offen offset:0 nt
    v_mov_b32_dpp v19, v45 row_newbcast:13 row_mask:0xf bank_mask:0xf
    v_and_b32 v16, v19, v2
    v_and_b32 v17, v19, v3
    v_and_b32 v18, v19, v4
    v_and_b32 v19, v19, v5
    s_waitcnt vmcnt(6)
    v_mfma_f32_16x16x32_bf16 v[40:43], v[72:75], v[12:15], v[40:43]
    s_cmp_eq_u32 s80, 1
    s_cbranch_scc1 L_bw58
    s_waitcnt vmcnt(4)
    s_cmp_eq_u32 s80, 0
    s_cbranch_scc1 L_bw58
    s_waitcnt vmcnt(3)
L_bw58:
    buffer_load_dwordx4 v[72:75], v1, s[44:47], s8 offen offset:1024 nt
    v_mov_b32_dpp v15, v45 row_newbcast:3 row_mask:0xf bank_mask:0xf
    v_and_b32 v12, v15, v2
    v_and_b32 v13, v15, v3
    v_and_b32 v14, v15, v4
    v_and_b32 v15, v15, v5
    s_waitcnt vmcnt(6)
    v_mfma_f32_16x16x32_bf16 v[40:43], v[76:79], v[16:19], v[40:43]
    s_cmp_eq_u32 s80, 1
    s_cbranch_scc1 L_bw59
    s_waitcnt vmcnt(4)
    s_cmp_eq_u32 s80, 0
    s_cbranch_scc1 L_bw59
    s_waitcnt vmcnt(3)
L_bw59:
    buffer_load_dwordx4 v[76:79], v1, s[44:47], s8 offen offset:2048 nt
    v_mov_b32_dpp v19, v45 row_newbcast:11 row_mask:0xf bank_mask:0xf
    v_and_b32 v16, v19, v2
    v_and_b32 v17, v19, v3
    v_and_b32 v18, v19, v4
    v_and_b32 v19, v19, v5
    s_waitcnt vmcnt(6)
    v_mfma_f32_16x16x32_bf16 v[40:43], v[84:87], v[12:15], v[40:43]
    s_cmp_eq_u32 s80, 1
    s_cbranch_scc1 L_bw60
    s_waitcnt vmcnt(4)
    s_cmp_eq_u32 s80, 0
    s_cbranch_scc1 L_bw60
    s_waitcnt vmcnt(3)
L_bw60:
    buffer_load_dwordx4 v[84:87], v1, s[44:47], s8 offen offset:3072 nt
    v_mov_b32_dpp v15, v45 row_newbcast:7 row_mask:0xf bank_mask:0xf
    v_and_b32 v12, v15, v2
    v_and_b32 v13, v15, v3
    v_and_b32 v14, v15, v4
    v_and_b32 v15, v15, v5
    s_waitcnt vmcnt(6)
    v_mfma_f32_16x16x32_bf16 v[40:43], v[88:91], v[16:19], v[40:43]
    s_cmp_gt_i32 s81, 0
    s_cselect_b32 s80, 1, 0
    s_cmp_lt_i32 s81, 0
    s_cselect_b32 s9, 1, 0
    s_sub_u32 s81, s81, s80
    s_add_u32 s81, s81, s9
    s_lshl1_add_u32 s80, s9, s80
    s_cmp_eq_u32 s80, 1
    s_cbranch_scc1 L_bw61
    s_waitcnt vmcnt(4)
    s_cmp_eq_u32 s80, 0
    s_cbranch_scc1 L_bw61
    s_waitcnt vmcnt(3)
L_bw61:
    s_mov_b32 s8, 278528
    buffer_load_dwordx4 v[88:91], v1, s[44:47], s8 offen offset:0 nt
    v_mov_b32_dpp v19, v45 row_newbcast:15 row_mask:0xf bank_mask:0xf
    v_and_b32 v16, v19, v2
    v_and_b32 v17, v19, v3
    v_and_b32 v18, v19, v4
    v_and_b32 v19, v19, v5
    s_waitcnt vmcnt(6)
    v_mfma_f32_16x16x32_bf16 v[40:43], v[64:67], v[12:15], v[40:43]
    s_cmp_eq_u32 s80, 1
    s_cbranch_scc1 L_bw62
    s_waitcnt vmcnt(4)
    s_cmp_eq_u32 s80, 0
    s_cbranch_scc1 L_bw62
    s_waitcnt vmcnt(3)
L_bw62:
    buffer_load_dwordx4 v[64:67], v1, s[44:47], s8 offen offset:1024 nt
    v_mov_b32_dpp v15, v46 row_newbcast:0 row_mask:0xf bank_mask:0xf
    v_and_b32 v12, v15, v2
    v_and_b32 v13, v15, v3
    v_and_b32 v14, v15, v4
    v_and_b32 v15, v15, v5
    s_waitcnt vmcnt(6)
    v_mfma_f32_16x16x32_bf16 v[40:43], v[80:83], v[16:19], v[40:43]
    s_cmp_eq_u32 s80, 1
    s_cbranch_scc1 L_bw63
    s_waitcnt vmcnt(4)
    s_cmp_eq_u32 s80, 0
    s_cbranch_scc1 L_bw63
    s_waitcnt vmcnt(3)
L_bw63:
    buffer_load_dwordx4 v[80:83], v1, s[44:47], s8 offen offset:2048 nt
    v_mov_b32_dpp v19, v46 row_newbcast:8 row_mask:0xf bank_mask:0xf
    v_and_b32 v16, v19, v2
    v_and_b32 v17, v19, v3
    v_and_b32 v18, v19, v4
    v_and_b32 v19, v19, v5
    s_waitcnt vmcnt(6)
    v_mfma_f32_16x16x32_bf16 v[40:43], v[68:71], v[12:15], v[40:43]
    s_cmp_eq_u32 s80, 1
    s_cbranch_scc1 L_bw64
    s_waitcnt vmcnt(4)
    s_cmp_eq_u32 s80, 0
    s_cbranch_scc1 L_bw64
    s_waitcnt vmcnt(3)
L_bw64:
    buffer_load_dwordx4 v[68:71], v1, s[44:47], s8 offen offset:3072 nt
    v_mov_b32_dpp v15, v46 row_newbcast:4 row_mask:0xf bank_mask:0xf
    v_and_b32 v12, v15, v2
    v_and_b32 v13, v15, v3
    v_and_b32 v14, v15, v4
    v_and_b32 v15, v15, v5
    s_waitcnt vmcnt(6)
    v_mfma_f32_16x16x32_bf16 v[40:43], v[72:75], v[16:19], v[40:43]
    s_cmp_gt_i32 s81, 0
    s_cselect_b32 s80, 1, 0
    s_cmp_lt_i32 s81, 0
    s_cselect_b32 s9, 1, 0
    s_sub_u32 s81, s81, s80
    s_add_u32 s81, s81, s9
    s_lshl1_add_u32 s80, s9, s80
    s_cmp_eq_u32 s80, 1
    s_cbranch_scc1 L_bw65
    s_waitcnt vmcnt(4)
    s_cmp_eq_u32 s80, 0
    s_cbranch_scc1 L_bw65
    s_waitcnt vmcnt(3)
L_bw65:
    s_mov_b32 s8, 327680
    buffer_load_dwordx4 v[72:75], v1, s[44:47], s8 offen offset:0 nt
    v_mov_b32_dpp v19, v46 row_newbcast:12 row_mask:0xf bank_mask:0xf
    v_and_b32 v16, v19, v2
    v_and_b32 v17, v19, v3
    v_and_b32 v18, v19, v4
    v_and_b32 v19, v19, v5
    s_waitcnt vmcnt(6)
    v_mfma_f32_16x16x32_bf16 v[40:43], v[76:79], v[12:15], v[40:43]
    s_cmp_eq_u32 s80, 1
    s_cbranch_scc1 L_bw66
    s_waitcnt vmcnt(4)
    s_cmp_eq_u32 s80, 0
    s_cbranch_scc1 L_bw66
    s_waitcnt vmcnt(3)
L_bw66:
    buffer_load_dwordx4 v[76:79], v1, s[44:47], s8 offen offset:1024 nt
    v_mov_b32_dpp v15, v46 row_newbcast:2 row_mask:0xf bank_mask:0xf
    v_and_b32 v12, v15, v2
    v_and_b32 v13, v15, v3
    v_and_b32 v14, v15, v4
    v_and_b32 v15, v15, v5
    s_waitcnt vmcnt(6)
    v_mfma_f32_16x16x32_bf16 v[40:43], v[84:87], v[16:19], v[40:43]
    s_cmp_eq_u32 s80, 1
    s_cbranch_scc1 L_bw67
    s_waitcnt vmcnt(4)
    s_cmp_eq_u32 s80, 0
    s_cbranch_scc1 L_bw67
    s_waitcnt vmcnt(3)
L_bw67:
    buffer_load_dwordx4 v[84:87], v1, s[44:47], s8 offen offset:2048 nt
    v_mov_b32_dpp v19, v46 row_newbcast:10 row_mask:0xf bank_mask:0xf
    v_and_b32 v16, v19, v2
    v_and_b32 v17, v19, v3
    v_and_b32 v18, v19, v4
    v_and_b32 v19, v19, v5
    s_waitcnt vmcnt(6)
    v_mfma_f32_16x16x32_bf16 v[40:43], v[88:91], v[12:15], v[40:43]
    s_cmp_eq_u32 s80, 1
    s_cbranch_scc1 L_bw68
    s_waitcnt vmcnt(4)
    s_cmp_eq_u32 s80, 0
    s_cbranch_scc1 L_bw68
    s_waitcnt vmcnt(3)
L_bw68:
    buffer_load_dwordx4 v[88:91], v1, s[44:47], s8 offen offset:3072 nt
    v_mov_b32_dpp v15, v46 row_newbcast:6 row_mask:0xf bank_mask:0xf
    v_and_b32 v12, v15, v2
    v_and_b32 v13, v15, v3
    v_and_b32 v14, v15, v4
    v_and_b32 v15, v15, v5
    s_waitcnt vmcnt(6)
    v_mfma_f32_16x16x32_bf16 v[40:43], v[64:67], v[16:19], v[40:43]
    s_cmp_gt_i32 s81, 0
    s_cselect_b32 s80, 1, 0
    s_cmp_lt_i32 s81, 0
    s_cselect_b32 s9, 1, 0
    s_sub_u32 s81, s81, s80
    s_add_u32 s81, s81, s9
    s_lshl1_add_u32 s80, s9, s80
    s_cmp_eq_u32 s80, 1
    s_cbranch_scc1 L_bw69
    s_waitcnt vmcnt(4)
    s_cmp_eq_u32 s80, 0
    s_cbranch_scc1 L_bw69
    s_waitcnt vmcnt(3)
L_bw69:
    s_mov_b32 s8, 344064
    buffer_load_dwordx4 v[64:67], v1, s[44:47], s8 offen offset:0 nt
    v_mov_b32_dpp v19, v46 row_newbcast:14 row_mask:0xf bank_mask:0xf
    v_and_b32 v16, v19, v2
    v_and_b32 v17, v19, v3
    v_and_b32 v18, v19, v4
    v_and_b32 v19, v19, v5
    s_waitcnt vmcnt(6)
    v_mfma_f32_16x16x32_bf16 v[40:43], v[80:83], v[12:15], v[40:43]
    s_cmp_eq_u32 s80, 1
    s_cbranch_scc1 L_bw70
    s_waitcnt vmcnt(4)
    s_cmp_eq_u32 s80, 0
    s_cbranch_scc1 L_bw70
    s_waitcnt vmcnt(3)
L_bw70:
    buffer_load_dwordx4 v[80:83], v1, s[44:47], s8 offen offset:1024 nt
    v_mov_b32_dpp v15, v46 row_newbcast:1 row_mask:0xf bank_mask:0xf
    v_and_b32 v12, v15, v2
    v_and_b32 v13, v15, v3
    v_and_b32 v14, v15, v4
    v_and_b32 v15, v15, v5
    s_waitcnt vmcnt(6)
    v_mfma_f32_16x16x32_bf16 v[40:43], v[68:71], v[16:19], v[40:43]
    s_cmp_eq_u32 s80, 1
    s_cbranch_scc1 L_bw71
    s_waitcnt vmcnt(4)
    s_cmp_eq_u32 s80, 0
    s_cbranch_scc1 L_bw71
    s_waitcnt vmcnt(3)
L_bw71:
    buffer_load_dwordx4 v[68:71], v1, s[44:47], s8 offen offset:2048 nt
    v_mov_b32_dpp v19, v46 row_newbcast:9 row_mask:0xf bank_mask:0xf
    v_and_b32 v16, v19, v2
    v_and_b32 v17, v19, v3
    v_and_b32 v18, v19, v4
    v_and_b32 v19, v19, v5
    s_waitcnt vmcnt(6)
    v_mfma_f32_16x16x32_bf16 v[40:43], v[72:75], v[12:15], v[40:43]
    s_cmp_eq_u32 s80, 1
    s_cbranch_scc1 L_bw72
    s_waitcnt vmcnt(4)
    s_cmp_eq_u32 s80, 0
    s_cbranch_scc1 L_bw72
    s_waitcnt vmcnt(3)
L_bw72:
    buffer_load_dwordx4 v[72:75], v1, s[44:47], s8 offen offset:3072 nt
    v_mov_b32_dpp v15, v46 row_newbcast:5 row_mask:0xf bank_mask:0xf
    v_and_b32 v12, v15, v2
    v_and_b32 v13, v15, v3
    v_and_b32 v14, v15, v4
    v_and_b32 v15, v15, v5
    s_waitcnt vmcnt(6)
    v_mfma_f32_16x16x32_bf16 v[40:43], v[76:79], v[16:19], v[40:43]
    s_cmp_gt_i32 s81, 0
    s_cselect_b32 s80, 1, 0
    s_cmp_lt_i32 s81, 0
    s_cselect_b32 s9, 1, 0
    s_sub_u32 s81, s81, s80
    s_add_u32 s81, s81, s9
    s_lshl1_add_u32 s80, s9, s80
    s_cmp_eq_u32 s80, 1
    s_cbranch_scc1 L_bw73
    s_waitcnt vmcnt(4)
    s_cmp_eq_u32 s80, 0
    s_cbranch_scc1 L_bw73
    s_waitcnt vmcnt(3)
L_bw73:
    s_mov_b32 s8, 393216
    buffer_load_dwordx4 v[76:79], v1, s[44:47], s8 offen offset:0 nt
    v_mov_b32_dpp v19, v46 row_newbcast:13 row_mask:0xf bank_mask:0xf
    v_and_b32 v16, v19, v2
    v_and_b32 v17, v19, v3
    v_and_b32 v18, v19, v4
    v_and_b32 v19, v19, v5
    s_waitcnt vmcnt(6)
    v_mfma_f32_16x16x32_bf16 v[40:43], v[84:87], v[12:15], v[40:43]
    s_cmp_eq_u32 s80, 1
    s_cbranch_scc1 L_bw74
    s_waitcnt vmcnt(4)
    s_cmp_eq_u32 s80, 0
    s_cbranch_scc1 L_bw74
    s_waitcnt vmcnt(3)
L_bw74:
    buffer_load_dwordx4 v[84:87], v1, s[44:47], s8 offen offset:1024 nt
    v_mov_b32_dpp v15, v46 row_newbcast:3 row_mask:0xf bank_mask:0xf
    v_and_b32 v12, v15, v2
    v_and_b32 v13, v15, v3
    v_and_b32 v14, v15, v4
    v_and_b32 v15, v15, v5
    s_waitcnt vmcnt(6)
    v_mfma_f32_16x16x32_bf16 v[40:43], v[88:91], v[16:19], v[40:43]
    s_cmp_eq_u32 s80, 1
    s_cbranch_scc1 L_bw75
    s_waitcnt vmcnt(4)
    s_cmp_eq_u32 s80, 0
    s_cbranch_scc1 L_bw75
    s_waitcnt vmcnt(3)
L_bw75:
    buffer_load_dwordx4 v[88:91], v1, s[44:47], s8 offen offset:2048 nt
    v_mov_b32_dpp v19, v46 row_newbcast:11 row_mask:0xf bank_mask:0xf
    v_and_b32 v16, v19, v2
    v_and_b32 v17, v19, v3
    v_and_b32 v18, v19, v4
    v_and_b32 v19, v19, v5
    s_waitcnt vmcnt(6)
    v_mfma_f32_16x16x32_bf16 v[40:43], v[64:67], v[12:15], v[40:43]
    s_cmp_eq_u32 s80, 1
    s_cbranch_scc1 L_bw76
    s_waitcnt vmcnt(4)
    s_cmp_eq_u32 s80, 0
    s_cbranch_scc1 L_bw76
    s_waitcnt vmcnt(3)
L_bw76:
    buffer_load_dwordx4 v[64:67], v1, s[44:47], s8 offen offset:3072 nt
    v_mov_b32_dpp v15, v46 row_newbcast:7 row_mask:0xf bank_mask:0xf
    v_and_b32 v12, v15, v2
    v_and_b32 v13, v15, v3
    v_and_b32 v14, v15, v4
    v_and_b32 v15, v15, v5
    s_waitcnt vmcnt(6)
    v_mfma_f32_16x16x32_bf16 v[40:43], v[80:83], v[16:19], v[40:43]
    s_cmp_gt_i32 s81, 0
    s_cselect_b32 s80, 1, 0
    s_cmp_lt_i32 s81, 0
    s_cselect_b32 s9, 1, 0
    s_sub_u32 s81, s81, s80
    s_add_u32 s81, s81, s9
    s_lshl1_add_u32 s80, s9, s80
    s_cmp_eq_u32 s80, 1
    s_cbranch_scc1 L_bw77
    s_waitcnt vmcnt(4)
    s_cmp_eq_u32 s80, 0
    s_cbranch_scc1 L_bw77
    s_waitcnt vmcnt(3)
L_bw77:
    s_mov_b32 s8, 409600
    buffer_load_dwordx4 v[80:83], v1, s[44:47], s8 offen offset:0 nt
    v_mov_b32_dpp v19, v46 row_newbcast:15 row_mask:0xf bank_mask:0xf
    v_and_b32 v16, v19, v2
    v_and_b32 v17, v19, v3
    v_and_b32 v18, v19, v4
    v_and_b32 v19, v19, v5
    s_waitcnt vmcnt(6)
    v_mfma_f32_16x16x32_bf16 v[40:43], v[68:71], v[12:15], v[40:43]
    s_cmp_eq_u32 s80, 1
    s_cbranch_scc1 L_bw78
    s_waitcnt vmcnt(4)
    s_cmp_eq_u32 s80, 0
    s_cbranch_scc1 L_bw78
    s_waitcnt vmcnt(3)
L_bw78:
    buffer_load_dwordx4 v[68:71], v1, s[44:47], s8 offen offset:1024 nt
    v_mov_b32_dpp v15, v47 row_newbcast:0 row_mask:0xf bank_mask:0xf
    v_and_b32 v12, v15, v2
    v_and_b32 v13, v15, v3
    v_and_b32 v14, v15, v4
    v_and_b32 v15, v15, v5
    s_waitcnt vmcnt(6)
    v_mfma_f32_16x16x32_bf16 v[40:43], v[72:75], v[16:19], v[40:43]
    s_cmp_eq_u32 s80, 1
    s_cbranch_scc1 L_bw79
    s_waitcnt vmcnt(4)
    s_cmp_eq_u32 s80, 0
    s_cbranch_scc1 L_bw79
    s_waitcnt vmcnt(3)
L_bw79:
    buffer_load_dwordx4 v[72:75], v1, s[44:47], s8 offen offset:2048 nt
    v_mov_b32_dpp v19, v47 row_newbcast:8 row_mask:0xf bank_mask:0xf
    v_and_b32 v16, v19, v2
    v_and_b32 v17, v19, v3
    v_and_b32 v18, v19, v4
    v_and_b32 v19, v19, v5
    s_waitcnt vmcnt(6)
    v_mfma_f32_16x16x32_bf16 v[40:43], v[76:79], v[12:15], v[40:43]
    s_cmp_eq_u32 s80, 1
    s_cbranch_scc1 L_bw80
    s_waitcnt vmcnt(4)
    s_cmp_eq_u32 s80, 0
    s_cbranch_scc1 L_bw80
    s_waitcnt vmcnt(3)
L_bw80:
    buffer_load_dwordx4 v[76:79], v1, s[44:47], s8 offen offset:3072 nt
    v_mov_b32_dpp v15, v47 row_newbcast:4 row_mask:0xf bank_mask:0xf
    v_and_b32 v12, v15, v2
    v_and_b32 v13, v15, v3
    v_and_b32 v14, v15, v4
    v_and_b32 v15, v15, v5
    s_waitcnt vmcnt(6)
    v_mfma_f32_16x16x32_bf16 v[40:43], v[84:87], v[16:19], v[40:43]
    s_cmp_gt_i32 s81, 0
    s_cselect_b32 s80, 1, 0
    s_cmp_lt_i32 s81, 0
    s_cselect_b32 s9, 1, 0
    s_sub_u32 s81, s81, s80
    s_add_u32 s81, s81, s9
    s_lshl1_add_u32 s80, s9, s80
    s_cmp_eq_u32 s80, 1
    s_cbranch_scc1 L_bw81
    s_waitcnt vmcnt(4)
    s_cmp_eq_u32 s80, 0
    s_cbranch_scc1 L_bw81
    s_waitcnt vmcnt(3)
L_bw81:
    s_mov_b32 s8, 458752
    buffer_load_dwordx4 v[84:87], v1, s[44:47], s8 offen offset:0 nt
    v_mov_b32_dpp v19, v47 row_newbcast:12 row_mask:0xf bank_mask:0xf
    v_and_b32 v16, v19, v2
    v_and_b32 v17, v19, v3
    v_and_b32 v18, v19, v4
    v_and_b32 v19, v19, v5
    s_waitcnt vmcnt(6)
    v_mfma_f32_16x16x32_bf16 v[40:43], v[88:91], v[12:15], v[40:43]
    s_cmp_eq_u32 s80, 1
    s_cbranch_scc1 L_bw82
    s_waitcnt vmcnt(4)
    s_cmp_eq_u32 s80, 0
    s_cbranch_scc1 L_bw82
    s_waitcnt vmcnt(3)
L_bw82:
    buffer_load_dwordx4 v[88:91], v1, s[44:47], s8 offen offset:1024 nt
    v_mov_b32_dpp v15, v47 row_newbcast:2 row_mask:0xf bank_mask:0xf
    v_and_b32 v12, v15, v2
    v_and_b32 v13, v15, v3
    v_and_b32 v14, v15, v4
    v_and_b32 v15, v15, v5
    s_waitcnt vmcnt(6)
    v_mfma_f32_16x16x32_bf16 v[40:43], v[64:67], v[16:19], v[40:43]
    s_cmp_eq_u32 s80, 1
    s_cbranch_scc1 L_bw83
    s_waitcnt vmcnt(4)
    s_cmp_eq_u32 s80, 0
    s_cbranch_scc1 L_bw83
    s_waitcnt vmcnt(3)
L_bw83:
    buffer_load_dwordx4 v[64:67], v1, s[44:47], s8 offen offset:2048 nt
    v_mov_b32_dpp v19, v47 row_newbcast:10 row_mask:0xf bank_mask:0xf
    v_and_b32 v16, v19, v2
    v_and_b32 v17, v19, v3
    v_and_b32 v18, v19, v4
    v_and_b32 v19, v19, v5
    s_waitcnt vmcnt(6)
    v_mfma_f32_16x16x32_bf16 v[40:43], v[80:83], v[12:15], v[40:43]
    s_cmp_eq_u32 s80, 1
    s_cbranch_scc1 L_bw84
    s_waitcnt vmcnt(4)
    s_cmp_eq_u32 s80, 0
    s_cbranch_scc1 L_bw84
    s_waitcnt vmcnt(3)
L_bw84:
    buffer_load_dwordx4 v[80:83], v1, s[44:47], s8 offen offset:3072 nt
    v_mov_b32_dpp v15, v47 row_newbcast:6 row_mask:0xf bank_mask:0xf
    v_and_b32 v12, v15, v2
    v_and_b32 v13, v15, v3
    v_and_b32 v14, v15, v4
    v_and_b32 v15, v15, v5
    s_waitcnt vmcnt(6)
    v_mfma_f32_16x16x32_bf16 v[40:43], v[68:71], v[16:19], v[40:43]
    s_cmp_gt_i32 s81, 0
    s_cselect_b32 s80, 1, 0
    s_cmp_lt_i32 s81, 0
    s_cselect_b32 s9, 1, 0
    s_sub_u32 s81, s81, s80
    s_add_u32 s81, s81, s9
    s_lshl1_add_u32 s80, s9, s80
    s_cmp_eq_u32 s80, 1
    s_cbranch_scc1 L_bw85
    s_waitcnt vmcnt(4)
    s_cmp_eq_u32 s80, 0
    s_cbranch_scc1 L_bw85
    s_waitcnt vmcnt(3)
L_bw85:
    s_mov_b32 s8, 475136
    buffer_load_dwordx4 v[68:71], v1, s[44:47], s8 offen offset:0 nt
    v_mov_b32_dpp v19, v47 row_newbcast:14 row_mask:0xf bank_mask:0xf
    v_and_b32 v16, v19, v2
    v_and_b32 v17, v19, v3
    v_and_b32 v18, v19, v4
    v_and_b32 v19, v19, v5
    s_waitcnt vmcnt(6)
    v_mfma_f32_16x16x32_bf16 v[40:43], v[72:75], v[12:15], v[40:43]
    s_cmp_eq_u32 s80, 1
    s_cbranch_scc1 L_bw86
    s_waitcnt vmcnt(4)
    s_cmp_eq_u32 s80, 0
    s_cbranch_scc1 L_bw86
    s_waitcnt vmcnt(3)
L_bw86:
    buffer_load_dwordx4 v[72:75], v1, s[44:47], s8 offen offset:1024 nt
    v_mov_b32_dpp v15, v47 row_newbcast:1 row_mask:0xf bank_mask:0xf
    v_and_b32 v12, v15, v2
    v_and_b32 v13, v15, v3
    v_and_b32 v14, v15, v4
    v_and_b32 v15, v15, v5
    s_waitcnt vmcnt(6)
    v_mfma_f32_16x16x32_bf16 v[40:43], v[76:79], v[16:19], v[40:43]
    s_cmp_eq_u32 s80, 1
    s_cbranch_scc1 L_bw87
    s_waitcnt vmcnt(4)
    s_cmp_eq_u32 s80, 0
    s_cbranch_scc1 L_bw87
    s_waitcnt vmcnt(3)
L_bw87:
    buffer_load_dwordx4 v[76:79], v1, s[44:47], s8 offen offset:2048 nt
    v_mov_b32_dpp v19, v47 row_newbcast:9 row_mask:0xf bank_mask:0xf
    v_and_b32 v16, v19, v2
    v_and_b32 v17, v19, v3
    v_and_b32 v18, v19, v4
    v_and_b32 v19, v19, v5
    s_waitcnt vmcnt(6)
    v_mfma_f32_16x16x32_bf16 v[40:43], v[84:87], v[12:15], v[40:43]
    s_cmp_eq_u32 s80, 1
    s_cbranch_scc1 L_bw88
    s_waitcnt vmcnt(4)
    s_cmp_eq_u32 s80, 0
    s_cbranch_scc1 L_bw88
    s_waitcnt vmcnt(3)
L_bw88:
    buffer_load_dwordx4 v[84:87], v1, s[44:47], s8 offen offset:3072 nt
    v_mov_b32_dpp v15, v47 row_newbcast:5 row_mask:0xf bank_mask:0xf
    v_and_b32 v12, v15, v2
    v_and_b32 v13, v15, v3
    v_and_b32 v14, v15, v4
    v_and_b32 v15, v15, v5
    s_waitcnt vmcnt(6)
    v_mfma_f32_16x16x32_bf16 v[40:43], v[88:91], v[16:19], v[40:43]
    s_memrealtime s[84:85]
    s_cmp_gt_i32 s81, 0
    s_cselect_b32 s80, 1, 0
    s_cmp_lt_i32 s81, 0
    s_cselect_b32 s9, 1, 0
    s_sub_u32 s81, s81, s80
    s_add_u32 s81, s81, s9
    s_lshl1_add_u32 s80, s9, s80
    s_cmp_eq_u32 s80, 1
    s_cbranch_scc1 L_bw89
    s_waitcnt vmcnt(4)
    s_cmp_eq_u32 s80, 0
    s_cbranch_scc1 L_bw89
    s_waitcnt vmcnt(3)
L_bw89:
    s_mov_b32 s8, 524288
    buffer_load_dwordx4 v[88:91], v1, s[44:47], s8 offen offset:0 nt
    v_mov_b32_dpp v19, v47 row_newbcast:13 row_mask:0xf bank_mask:0xf
    v_and_b32 v16, v19, v2
    v_and_b32 v17, v19, v3
    v_and_b32 v18, v19, v4
    v_and_b32 v19, v19, v5
    s_waitcnt vmcnt(6)
    v_mfma_f32_16x16x32_bf16 v[40:43], v[64:67], v[12:15], v[40:43]
    s_waitcnt lgkmcnt(0)
    s_cmp_eq_u32 s15, 0
    s_cbranch_scc0 L_cp90
    v_mov_b32 v30, s84
    v_mov_b32 v31, s90
    s_add_u32 s9, s83, 4096
    s_mov_b64 exec, 1
    buffer_store_dwordx2 v[30:31], v8, s[76:79], s9 offen
    s_mov_b64 exec, -1
L_cp90:
    s_cmp_eq_u32 s80, 1
    s_cbranch_scc1 L_bw91
    s_waitcnt vmcnt(4)
    s_cmp_eq_u32 s80, 0
    s_cbranch_scc1 L_bw91
    s_waitcnt vmcnt(3)
L_bw91:
    buffer_load_dwordx4 v[64:67], v1, s[44:47], s8 offen offset:1024 nt
    v_mov_b32_dpp v15, v47 row_newbcast:3 row_mask:0xf bank_mask:0xf
    v_and_b32 v12, v15, v2
    v_and_b32 v13, v15, v3
    v_and_b32 v14, v15, v4
    v_and_b32 v15, v15, v5
    s_waitcnt vmcnt(6)
    v_mfma_f32_16x16x32_bf16 v[40:43], v[80:83], v[16:19], v[40:43]
    s_cmp_eq_u32 s80, 1
    s_cbranch_scc1 L_bw92
    s_waitcnt vmcnt(4)
    s_cmp_eq_u32 s80, 0
    s_cbranch_scc1 L_bw92
    s_waitcnt vmcnt(3)
L_bw92:
    buffer_load_dwordx4 v[80:83], v1, s[44:47], s8 offen offset:2048 nt
    v_mov_b32_dpp v19, v47 row_newbcast:11 row_mask:0xf bank_mask:0xf
    v_and_b32 v16, v19, v2
    v_and_b32 v17, v19, v3
    v_and_b32 v18, v19, v4
    v_and_b32 v19, v19, v5
    s_waitcnt vmcnt(6)
    v_mfma_f32_16x16x32_bf16 v[40:43], v[68:71], v[12:15], v[40:43]
    s_cmp_eq_u32 s80, 1
    s_cbranch_scc1 L_bw93
    s_waitcnt vmcnt(4)
    s_cmp_eq_u32 s80, 0
    s_cbranch_scc1 L_bw93
    s_waitcnt vmcnt(3)
L_bw93:
    buffer_load_dwordx4 v[68:71], v1, s[44:47], s8 offen offset:3072 nt
    v_mov_b32_dpp v15, v47 row_newbcast:7 row_mask:0xf bank_mask:0xf
    v_and_b32 v12, v15, v2
    v_and_b32 v13, v15, v3
    v_and_b32 v14, v15, v4
    v_and_b32 v15, v15, v5
    s_waitcnt vmcnt(6)
    v_mfma_f32_16x16x32_bf16 v[40:43], v[72:75], v[16:19], v[40:43]
    s_cmp_gt_i32 s81, 0
    s_cselect_b32 s80, 1, 0
    s_cmp_lt_i32 s81, 0
    s_cselect_b32 s9, 1, 0
    s_sub_u32 s81, s81, s80
    s_add_u32 s81, s81, s9
    s_lshl1_add_u32 s80, s9, s80
    s_cmp_eq_u32 s80, 1
    s_cbranch_scc1 L_bw94
    s_waitcnt vmcnt(4)
    s_cmp_eq_u32 s80, 0
    s_cbranch_scc1 L_bw94
    s_waitcnt vmcnt(3)
L_bw94:
    s_mov_b32 s8, 540672
    buffer_load_dwordx4 v[72:75], v1, s[44:47], s8 offen offset:0 nt
    v_mov_b32_dpp v19, v47 row_newbcast:15 row_mask:0xf bank_mask:0xf
    v_and_b32 v16, v19, v2
    v_and_b32 v17, v19, v3
    v_and_b32 v18, v19, v4
    v_and_b32 v19, v19, v5
    s_waitcnt vmcnt(6)
    v_mfma_f32_16x16x32_bf16 v[40:43], v[76:79], v[12:15], v[40:43]
    s_cmp_eq_u32 s80, 1
    s_cbranch_scc1 L_bw95
    s_waitcnt vmcnt(4)
    s_cmp_eq_u32 s80, 0
    s_cbranch_scc1 L_bw95
    s_waitcnt vmcnt(3)
L_bw95:
    buffer_load_dwordx4 v[76:79], v1, s[44:47], s8 offen offset:1024 nt
    v_mov_b32_dpp v15, v48 row_newbcast:0 row_mask:0xf bank_mask:0xf
    v_and_b32 v12, v15, v2
    v_and_b32 v13, v15, v3
    v_and_b32 v14, v15, v4
    v_and_b32 v15, v15, v5
    s_waitcnt vmcnt(6)
    v_mfma_f32_16x16x32_bf16 v[40:43], v[84:87], v[16:19], v[40:43]
    s_cmp_eq_u32 s80, 1
    s_cbranch_scc1 L_bw96
    s_waitcnt vmcnt(4)
    s_cmp_eq_u32 s80, 0
    s_cbranch_scc1 L_bw96
    s_waitcnt vmcnt(3)
L_bw96:
    buffer_load_dwordx4 v[84:87], v1, s[44:47], s8 offen offset:2048 nt
    v_mov_b32_dpp v19, v48 row_newbcast:8 row_mask:0xf bank_mask:0xf
    v_and_b32 v16, v19, v2
    v_and_b32 v17, v19, v3
    v_and_b32 v18, v19, v4
    v_and_b32 v19, v19, v5
    s_waitcnt vmcnt(6)
    v_mfma_f32_16x16x32_bf16 v[40:43], v[88:91], v[12:15], v[40:43]
    s_cmp_eq_u32 s80, 1
    s_cbranch_scc1 L_bw97
    s_waitcnt vmcnt(4)
    s_cmp_eq_u32 s80, 0
    s_cbranch_scc1 L_bw97
    s_waitcnt vmcnt(3)
L_bw97:
    buffer_load_dwordx4 v[88:91], v1, s[44:47], s8 offen offset:3072 nt
    v_mov_b32_dpp v15, v48 row_newbcast:4 row_mask:0xf bank_mask:0xf
    v_and_b32 v12, v15, v2
    v_and_b32 v13, v15, v3
    v_and_b32 v14, v15, v4
    v_and_b32 v15, v15, v5
    s_waitcnt vmcnt(6)
    v_mfma_f32_16x16x32_bf16 v[40:43], v[64:67], v[16:19], v[40:43]
    s_cmp_gt_i32 s81, 0
    s_cselect_b32 s80, 1, 0
    s_cmp_lt_i32 s81, 0
    s_cselect_b32 s9, 1, 0
    s_sub_u32 s81, s81, s80
    s_add_u32 s81, s81, s9
    s_lshl1_add_u32 s80, s9, s80
    s_cmp_eq_u32 s80, 1
    s_cbranch_scc1 L_bw98
    s_waitcnt vmcnt(4)
    s_cmp_eq_u32 s80, 0
    s_cbranch_scc1 L_bw98
    s_waitcnt vmcnt(3)
L_bw98:
    s_mov_b32 s8, 589824
    buffer_load_dwordx4 v[64:67], v1, s[44:47], s8 offen offset:0 nt
    v_mov_b32_dpp v19, v48 row_newbcast:12 row_mask:0xf bank_mask:0xf
    v_and_b32 v16, v19, v2
    v_and_b32 v17, v19, v3
    v_and_b32 v18, v19, v4
    v_and_b32 v19, v19, v5
    s_waitcnt vmcnt(6)
    v_mfma_f32_16x16x32_bf16 v[40:43], v[80:83], v[12:15], v[40:43]
    s_cmp_eq_u32 s80, 1
    s_cbranch_scc1 L_bw99
    s_waitcnt vmcnt(4)
    s_cmp_eq_u32 s80, 0
    s_cbranch_scc1 L_bw99
    s_waitcnt vmcnt(3)
L_bw99:
    buffer_load_dwordx4 v[80:83], v1, s[44:47], s8 offen offset:1024 nt
    v_mov_b32_dpp v15, v48 row_newbcast:2 row_mask:0xf bank_mask:0xf
    v_and_b32 v12, v15, v2
    v_and_b32 v13, v15, v3
    v_and_b32 v14, v15, v4
    v_and_b32 v15, v15, v5
    s_waitcnt vmcnt(6)
    v_mfma_f32_16x16x32_bf16 v[40:43], v[68:71], v[16:19], v[40:43]
    s_cmp_eq_u32 s80, 1
    s_cbranch_scc1 L_bw100
    s_waitcnt vmcnt(4)
    s_cmp_eq_u32 s80, 0
    s_cbranch_scc1 L_bw100
    s_waitcnt vmcnt(3)
L_bw100:
    buffer_load_dwordx4 v[68:71], v1, s[44:47], s8 offen offset:2048 nt
    v_mov_b32_dpp v19, v48 row_newbcast:10 row_mask:0xf bank_mask:0xf
    v_and_b32 v16, v19, v2
    v_and_b32 v17, v19, v3
    v_and_b32 v18, v19, v4
    v_and_b32 v19, v19, v5
    s_waitcnt vmcnt(6)
    v_mfma_f32_16x16x32_bf16 v[40:43], v[72:75], v[12:15], v[40:43]
    s_cmp_eq_u32 s80, 1
    s_cbranch_scc1 L_bw101
    s_waitcnt vmcnt(4)
    s_cmp_eq_u32 s80, 0
    s_cbranch_scc1 L_bw101
    s_waitcnt vmcnt(3)
L_bw101:
    buffer_load_dwordx4 v[72:75], v1, s[44:47], s8 offen offset:3072 nt
    v_mov_b32_dpp v15, v48 row_newbcast:6 row_mask:0xf bank_mask:0xf
    v_and_b32 v12, v15, v2
    v_and_b32 v13, v15, v3
    v_and_b32 v14, v15, v4
    v_and_b32 v15, v15, v5
    s_waitcnt vmcnt(6)
    v_mfma_f32_16x16x32_bf16 v[40:43], v[76:79], v[16:19], v[40:43]
    s_add_u32 s9, s82, 4096
    buffer_load_dwordx2 v[32:33], v34, s[76:79], s9 offen sc1
    s_cmp_gt_i32 s81, 0
    s_cselect_b32 s80, 1, 0
    s_cmp_lt_i32 s81, 0
    s_cselect_b32 s9, 1, 0
    s_sub_u32 s81, s81, s80
    s_add_u32 s81, s81, s9
    s_lshl1_add_u32 s80, s9, s80
    s_cmp_eq_u32 s80, 1
    s_cbranch_scc1 L_bw102
    s_waitcnt vmcnt(5)
    s_cmp_eq_u32 s80, 0
    s_cbranch_scc1 L_bw102
    s_waitcnt vmcnt(4)
L_bw102:
    s_mov_b32 s8, 606208
    buffer_load_dwordx4 v[76:79], v1, s[44:47], s8 offen offset:0 nt
    v_mov_b32_dpp v19, v48 row_newbcast:14 row_mask:0xf bank_mask:0xf
    v_and_b32 v16, v19, v2
    v_and_b32 v17, v19, v3
    v_and_b32 v18, v19, v4
    v_and_b32 v19, v19, v5
    s_waitcnt vmcnt(7)
    v_mfma_f32_16x16x32_bf16 v[40:43], v[84:87], v[12:15], v[40:43]
    s_cmp_eq_u32 s80, 1
    s_cbranch_scc1 L_bw103
    s_waitcnt vmcnt(5)
    s_cmp_eq_u32 s80, 0
    s_cbranch_scc1 L_bw103
    s_waitcnt vmcnt(4)
L_bw103:
    buffer_load_dwordx4 v[84:87], v1, s[44:47], s8 offen offset:1024 nt
    v_mov_b32_dpp v15, v48 row_newbcast:1 row_mask:0xf bank_mask:0xf
    v_and_b32 v12, v15, v2
    v_and_b32 v13, v15, v3
    v_and_b32 v14, v15, v4
    v_and_b32 v15, v15, v5
    s_waitcnt vmcnt(7)
    v_mfma_f32_16x16x32_bf16 v[40:43], v[88:91], v[16:19], v[40:43]
    s_cmp_eq_u32 s80, 1
    s_cbranch_scc1 L_bw104
    s_waitcnt vmcnt(5)
    s_cmp_eq_u32 s80, 0
    s_cbranch_scc1 L_bw104
    s_waitcnt vmcnt(4)
L_bw104:
    buffer_load_dwordx4 v[88:91], v1, s[44:47], s8 offen offset:2048 nt
    v_mov_b32_dpp v19, v48 row_newbcast:9 row_mask:0xf bank_mask:0xf
    v_and_b32 v16, v19, v2
    v_and_b32 v17, v19, v3
    v_and_b32 v18, v19, v4
    v_and_b32 v19, v19, v5
    s_waitcnt vmcnt(7)
    v_mfma_f32_16x16x32_bf16 v[40:43], v[64:67], v[12:15], v[40:43]
    s_cmp_eq_u32 s80, 1
    s_cbranch_scc1 L_bw105
    s_waitcnt vmcnt(5)
    s_cmp_eq_u32 s80, 0
    s_cbranch_scc1 L_bw105
    s_waitcnt vmcnt(4)
L_bw105:
    buffer_load_dwordx4 v[64:67], v1, s[44:47], s8 offen offset:3072 nt
    v_mov_b32_dpp v15, v48 row_newbcast:5 row_mask:0xf bank_mask:0xf
    v_and_b32 v12, v15, v2
    v_and_b32 v13, v15, v3
    v_and_b32 v14, v15, v4
    v_and_b32 v15, v15, v5
    s_waitcnt vmcnt(7)
    v_mfma_f32_16x16x32_bf16 v[40:43], v[80:83], v[16:19], v[40:43]
    s_cmp_gt_i32 s81, 0
    s_cselect_b32 s80, 1, 0
    s_cmp_lt_i32 s81, 0
    s_cselect_b32 s9, 1, 0
    s_sub_u32 s81, s81, s80
    s_add_u32 s81, s81, s9
    s_lshl1_add_u32 s80, s9, s80
    s_cmp_eq_u32 s80, 1
    s_cbranch_scc1 L_bw106
    s_waitcnt vmcnt(5)
    s_cmp_eq_u32 s80, 0
    s_cbranch_scc1 L_bw106
    s_waitcnt vmcnt(3)
L_bw106:
    s_mov_b32 s8, 655360
    buffer_load_dwordx4 v[80:83], v1, s[44:47], s8 offen offset:0 nt
    v_mov_b32_dpp v19, v48 row_newbcast:13 row_mask:0xf bank_mask:0xf
    v_and_b32 v16, v19, v2
    v_and_b32 v17, v19, v3
    v_and_b32 v18, v19, v4
    v_and_b32 v19, v19, v5
    s_waitcnt vmcnt(7)
    v_mfma_f32_16x16x32_bf16 v[40:43], v[68:71], v[12:15], v[40:43]
    s_cmp_eq_u32 s80, 1
    s_cbranch_scc1 L_bw107
    s_waitcnt vmcnt(4)
    s_cmp_eq_u32 s80, 0
    s_cbranch_scc1 L_bw107
    s_waitcnt vmcnt(3)
L_bw107:
    buffer_load_dwordx4 v[68:71], v1, s[44:47], s8 offen offset:1024 nt
    v_mov_b32_dpp v15, v48 row_newbcast:3 row_mask:0xf bank_mask:0xf
    v_and_b32 v12, v15, v2
    v_and_b32 v13, v15, v3
    v_and_b32 v14, v15, v4
    v_and_b32 v15, v15, v5
    s_waitcnt vmcnt(7)
    v_mfma_f32_16x16x32_bf16 v[40:43], v[72:75], v[16:19], v[40:43]
    s_cmp_eq_u32 s80, 1
    s_cbranch_scc1 L_bw108
    s_waitcnt vmcnt(4)
    s_cmp_eq_u32 s80, 0
    s_cbranch_scc1 L_bw108
    s_waitcnt vmcnt(3)
L_bw108:
    buffer_load_dwordx4 v[72:75], v1, s[44:47], s8 offen offset:2048 nt
    v_mov_b32_dpp v19, v48 row_newbcast:11 row_mask:0xf bank_mask:0xf
    v_and_b32 v16, v19, v2
    v_and_b32 v17, v19, v3
    v_and_b32 v18, v19, v4
    v_and_b32 v19, v19, v5
    s_waitcnt vmcnt(6)
    v_mfma_f32_16x16x32_bf16 v[40:43], v[76:79], v[12:15], v[40:43]
    s_cmp_eq_u32 s80, 1
    s_cbranch_scc1 L_bw109
    s_waitcnt vmcnt(4)
    s_cmp_eq_u32 s80, 0
    s_cbranch_scc1 L_bw109
    s_waitcnt vmcnt(3)
L_bw109:
    buffer_load_dwordx4 v[76:79], v1, s[44:47], s8 offen offset:3072 nt
    v_mov_b32_dpp v15, v48 row_newbcast:7 row_mask:0xf bank_mask:0xf
    v_and_b32 v12, v15, v2
    v_and_b32 v13, v15, v3
    v_and_b32 v14, v15, v4
    v_and_b32 v15, v15, v5
    s_waitcnt vmcnt(6)
    v_mfma_f32_16x16x32_bf16 v[40:43], v[84:87], v[16:19], v[40:43]
    v_cmp_eq_u32 vcc, s90, v33
    v_sub_u32 v32, s84, v32
    v_cvt_f32_i32 v32, v32
    v_mov_b32 v33, 0xc3480000
    v_cndmask_b32 v32, v33, v32, vcc
    s_nop 1
    v_add_f32_dpp v32, v32, v32 row_ror:8 row_mask:0xf bank_mask:0xf
    s_nop 1
    v_add_f32_dpp v32, v32, v32 row_ror:4 row_mask:0xf bank_mask:0xf
    s_nop 1
    v_add_f32_dpp v32, v32, v32 row_ror:2 row_mask:0xf bank_mask:0xf
    s_nop 1
    v_add_f32_dpp v32, v32, v32 row_ror:1 row_mask:0xf bank_mask:0xf
    s_nop 1
    v_add_f32_dpp v32, v32, v32 row_bcast:15 row_mask:0xa bank_mask:0xf
    s_nop 1
    v_add_f32_dpp v32, v32, v32 row_bcast:31 row_mask:0xc bank_mask:0xf
    s_nop 0
    v_readlane_b32 s9, v32, 63
    v_mov_b32 v33, 0x3a8f5c29
    s_nop 0
    v_mul_f32 v32, s9, v33
    v_cvt_i32_f32 v32, v32
    v_med3_i32 v32, v32, -8, 8
    s_nop 0
    v_readfirstlane_b32 s81, v32
    s_nop 0
    s_cmp_gt_i32 s81, 0
    s_cselect_b32 s80, 1, 0
    s_cmp_lt_i32 s81, 0
    s_cselect_b32 s9, 1, 0
    s_sub_u32 s81, s81, s80
    s_add_u32 s81, s81, s9
    s_lshl1_add_u32 s80, s9, s80
    s_cmp_eq_u32 s80, 1
    s_cbranch_scc1 L_bw110
    s_waitcnt vmcnt(4)
    s_cmp_eq_u32 s80, 0
    s_cbranch_scc1 L_bw110
    s_waitcnt vmcnt(3)
L_bw110:
    s_mov_b32 s8, 671744
    buffer_load_dwordx4 v[84:87], v1, s[44:47], s8 offen offset:0 nt
    v_mov_b32_dpp v19, v48 row_newbcast:15 row_mask:0xf bank_mask:0xf
    v_and_b32 v16, v19, v2
    v_and_b32 v17, v19, v3
    v_and_b32 v18, v19, v4
    v_and_b32 v19, v19, v5
    s_waitcnt vmcnt(6)
    v_mfma_f32_16x16x32_bf16 v[40:43], v[88:91], v[12:15], v[40:43]
    s_cmp_eq_u32 s80, 1
    s_cbranch_scc1 L_bw111
    s_waitcnt vmcnt(4)
    s_cmp_eq_u32 s80, 0
    s_cbranch_scc1 L_bw111
    s_waitcnt vmcnt(3)
L_bw111:
    buffer_load_dwordx4 v[88:91], v1, s[44:47], s8 offen offset:1024 nt
    v_mov_b32_dpp v15, v49 row_newbcast:0 row_mask:0xf bank_mask:0xf
    v_and_b32 v12, v15, v2
    v_and_b32 v13, v15, v3
    v_and_b32 v14, v15, v4
    v_and_b32 v15, v15, v5
    s_waitcnt vmcnt(6)
    v_mfma_f32_16x16x32_bf16 v[40:43], v[64:67], v[16:19], v[40:43]
    s_cmp_eq_u32 s80, 1
    s_cbranch_scc1 L_bw112
    s_waitcnt vmcnt(4)
    s_cmp_eq_u32 s80, 0
    s_cbranch_scc1 L_bw112
    s_waitcnt vmcnt(3)
L_bw112:
    buffer_load_dwordx4 v[64:67], v1, s[44:47], s8 offen offset:2048 nt
    v_mov_b32_dpp v19, v49 row_newbcast:8 row_mask:0xf bank_mask:0xf
    v_and_b32 v16, v19, v2
    v_and_b32 v17, v19, v3
    v_and_b32 v18, v19, v4
    v_and_b32 v19, v19, v5
    s_waitcnt vmcnt(6)
    v_mfma_f32_16x16x32_bf16 v[40:43], v[80:83], v[12:15], v[40:43]
    s_cmp_eq_u32 s80, 1
    s_cbranch_scc1 L_bw113
    s_waitcnt vmcnt(4)
    s_cmp_eq_u32 s80, 0
    s_cbranch_scc1 L_bw113
    s_waitcnt vmcnt(3)
L_bw113:
    buffer_load_dwordx4 v[80:83], v1, s[44:47], s8 offen offset:3072 nt
    v_mov_b32_dpp v15, v49 row_newbcast:4 row_mask:0xf bank_mask:0xf
    v_and_b32 v12, v15, v2
    v_and_b32 v13, v15, v3
    v_and_b32 v14, v15, v4
    v_and_b32 v15, v15, v5
    s_waitcnt vmcnt(6)
    v_mfma_f32_16x16x32_bf16 v[40:43], v[68:71], v[16:19], v[40:43]
    s_cmp_gt_i32 s81, 0
    s_cselect_b32 s80, 1, 0
    s_cmp_lt_i32 s81, 0
    s_cselect_b32 s9, 1, 0
    s_sub_u32 s81, s81, s80
    s_add_u32 s81, s81, s9
    s_lshl1_add_u32 s80, s9, s80
    s_cmp_eq_u32 s80, 1
    s_cbranch_scc1 L_bw114
    s_waitcnt vmcnt(4)
    s_cmp_eq_u32 s80, 0
    s_cbranch_scc1 L_bw114
    s_waitcnt vmcnt(3)
L_bw114:
    s_mov_b32 s8, 720896
    buffer_load_dwordx4 v[68:71], v1, s[44:47], s8 offen offset:0 nt
    v_mov_b32_dpp v19, v49 row_newbcast:12 row_mask:0xf bank_mask:0xf
    v_and_b32 v16, v19, v2
    v_and_b32 v17, v19, v3
    v_and_b32 v18, v19, v4
    v_and_b32 v19, v19, v5
    s_waitcnt vmcnt(6)
    v_mfma_f32_16x16x32_bf16 v[40:43], v[72:75], v[12:15], v[40:43]
    s_cmp_eq_u32 s80, 1
    s_cbranch_scc1 L_bw115
    s_waitcnt vmcnt(4)
    s_cmp_eq_u32 s80, 0
    s_cbranch_scc1 L_bw115
    s_waitcnt vmcnt(3)
L_bw115:
    buffer_load_dwordx4 v[72:75], v1, s[44:47], s8 offen offset:1024 nt
    v_mov_b32_dpp v15, v49 row_newbcast:2 row_mask:0xf bank_mask:0xf
    v_and_b32 v12, v15, v2
    v_and_b32 v13, v15, v3
    v_and_b32 v14, v15, v4
    v_and_b32 v15, v15, v5
    s_waitcnt vmcnt(6)
    v_mfma_f32_16x16x32_bf16 v[40:43], v[76:79], v[16:19], v[40:43]
    s_cmp_eq_u32 s80, 1
    s_cbranch_scc1 L_bw116
    s_waitcnt vmcnt(4)
    s_cmp_eq_u32 s80, 0
    s_cbranch_scc1 L_bw116
    s_waitcnt vmcnt(3)
L_bw116:
    buffer_load_dwordx4 v[76:79], v1, s[44:47], s8 offen offset:2048 nt
    v_mov_b32_dpp v19, v49 row_newbcast:10 row_mask:0xf bank_mask:0xf
    v_and_b32 v16, v19, v2
    v_and_b32 v17, v19, v3
    v_and_b32 v18, v19, v4
    v_and_b32 v19, v19, v5
    s_waitcnt vmcnt(6)
    v_mfma_f32_16x16x32_bf16 v[40:43], v[84:87], v[12:15], v[40:43]
    s_cmp_eq_u32 s80, 1
    s_cbranch_scc1 L_bw117
    s_waitcnt vmcnt(4)
    s_cmp_eq_u32 s80, 0
    s_cbranch_scc1 L_bw117
    s_waitcnt vmcnt(3)
L_bw117:
    buffer_load_dwordx4 v[84:87], v1, s[44:47], s8 offen offset:3072 nt
    v_mov_b32_dpp v15, v49 row_newbcast:6 row_mask:0xf bank_mask:0xf
    v_and_b32 v12, v15, v2
    v_and_b32 v13, v15, v3
    v_and_b32 v14, v15, v4
    v_and_b32 v15, v15, v5
    s_waitcnt vmcnt(6)
    v_mfma_f32_16x16x32_bf16 v[40:43], v[88:91], v[16:19], v[40:43]
    s_cmp_gt_i32 s81, 0
    s_cselect_b32 s80, 1, 0
    s_cmp_lt_i32 s81, 0
    s_cselect_b32 s9, 1, 0
    s_sub_u32 s81, s81, s80
    s_add_u32 s81, s81, s9
    s_lshl1_add_u32 s80, s9, s80
    s_cmp_eq_u32 s80, 1
    s_cbranch_scc1 L_bw118
    s_waitcnt vmcnt(4)
    s_cmp_eq_u32 s80, 0
    s_cbranch_scc1 L_bw118
    s_waitcnt vmcnt(3)
L_bw118:
    s_mov_b32 s8, 737280
    buffer_load_dwordx4 v[88:91], v1, s[44:47], s8 offen offset:0 nt
    v_mov_b32_dpp v19, v49 row_newbcast:14 row_mask:0xf bank_mask:0xf
    v_and_b32 v16, v19, v2
    v_and_b32 v17, v19, v3
    v_and_b32 v18, v19, v4
    v_and_b32 v19, v19, v5
    s_waitcnt vmcnt(6)
    v_mfma_f32_16x16x32_bf16 v[40:43], v[64:67], v[12:15], v[40:43]
    s_cmp_eq_u32 s80, 1
    s_cbranch_scc1 L_bw119
    s_waitcnt vmcnt(4)
    s_cmp_eq_u32 s80, 0
    s_cbranch_scc1 L_bw119
    s_waitcnt vmcnt(3)
L_bw119:
    buffer_load_dwordx4 v[64:67], v1, s[44:47], s8 offen offset:1024 nt
    v_mov_b32_dpp v15, v49 row_newbcast:1 row_mask:0xf bank_mask:0xf
    v_and_b32 v12, v15, v2
    v_and_b32 v13, v15, v3
    v_and_b32 v14, v15, v4
    v_and_b32 v15, v15, v5
    s_waitcnt vmcnt(6)
    v_mfma_f32_16x16x32_bf16 v[40:43], v[80:83], v[16:19], v[40:43]
    s_cmp_eq_u32 s80, 1
    s_cbranch_scc1 L_bw120
    s_waitcnt vmcnt(4)
    s_cmp_eq_u32 s80, 0
    s_cbranch_scc1 L_bw120
    s_waitcnt vmcnt(3)
L_bw120:
    buffer_load_dwordx4 v[80:83], v1, s[44:47], s8 offen offset:2048 nt
    v_mov_b32_dpp v19, v49 row_newbcast:9 row_mask:0xf bank_mask:0xf
    v_and_b32 v16, v19, v2
    v_and_b32 v17, v19, v3
    v_and_b32 v18, v19, v4
    v_and_b32 v19, v19, v5
    s_waitcnt vmcnt(6)
    v_mfma_f32_16x16x32_bf16 v[40:43], v[68:71], v[12:15], v[40:43]
    s_cmp_eq_u32 s80, 1
    s_cbranch_scc1 L_bw121
    s_waitcnt vmcnt(4)
    s_cmp_eq_u32 s80, 0
    s_cbranch_scc1 L_bw121
    s_waitcnt vmcnt(3)
L_bw121:
    buffer_load_dwordx4 v[68:71], v1, s[44:47], s8 offen offset:3072 nt
    v_mov_b32_dpp v15, v49 row_newbcast:5 row_mask:0xf bank_mask:0xf
    v_and_b32 v12, v15, v2
    v_and_b32 v13, v15, v3
    v_and_b32 v14, v15, v4
    v_and_b32 v15, v15, v5
    s_waitcnt vmcnt(6)
    v_mfma_f32_16x16x32_bf16 v[40:43], v[72:75], v[16:19], v[40:43]
    s_cmp_gt_i32 s81, 0
    s_cselect_b32 s80, 1, 0
    s_cmp_lt_i32 s81, 0
    s_cselect_b32 s9, 1, 0
    s_sub_u32 s81, s81, s80
    s_add_u32 s81, s81, s9
    s_lshl1_add_u32 s80, s9, s80
    s_cmp_eq_u32 s80, 1
    s_cbranch_scc1 L_bw122
    s_waitcnt vmcnt(4)
    s_cmp_eq_u32 s80, 0
    s_cbranch_scc1 L_bw122
    s_waitcnt vmcnt(3)
L_bw122:
    s_mov_b32 s8, 786432
    buffer_load_dwordx4 v[72:75], v1, s[44:47], s8 offen offset:0 nt
    v_mov_b32_dpp v19, v49 row_newbcast:13 row_mask:0xf bank_mask:0xf
    v_and_b32 v16, v19, v2
    v_and_b32 v17, v19, v3
    v_and_b32 v18, v19, v4
    v_and_b32 v19, v19, v5
    s_waitcnt vmcnt(6)
    v_mfma_f32_16x16x32_bf16 v[40:43], v[76:79], v[12:15], v[40:43]
    s_cmp_eq_u32 s80, 1
    s_cbranch_scc1 L_bw123
    s_waitcnt vmcnt(4)
    s_cmp_eq_u32 s80, 0
    s_cbranch_scc1 L_bw123
    s_waitcnt vmcnt(3)
L_bw123:
    buffer_load_dwordx4 v[76:79], v1, s[44:47], s8 offen offset:1024 nt
    v_mov_b32_dpp v15, v49 row_newbcast:3 row_mask:0xf bank_mask:0xf
    v_and_b32 v12, v15, v2
    v_and_b32 v13, v15, v3
    v_and_b32 v14, v15, v4
    v_and_b32 v15, v15, v5
    s_waitcnt vmcnt(6)
    v_mfma_f32_16x16x32_bf16 v[40:43], v[84:87], v[16:19], v[40:43]
    s_cmp_eq_u32 s80, 1
    s_cbranch_scc1 L_bw124
    s_waitcnt vmcnt(4)
    s_cmp_eq_u32 s80, 0
    s_cbranch_scc1 L_bw124
    s_waitcnt vmcnt(3)
L_bw124:
    buffer_load_dwordx4 v[84:87], v1, s[44:47], s8 offen offset:2048 nt
    v_mov_b32_dpp v19, v49 row_newbcast:11 row_mask:0xf bank_mask:0xf
    v_and_b32 v16, v19, v2
    v_and_b32 v17, v19, v3
    v_and_b32 v18, v19, v4
    v_and_b32 v19, v19, v5
    s_waitcnt vmcnt(6)
    v_mfma_f32_16x16x32_bf16 v[40:43], v[88:91], v[12:15], v[40:43]
    s_cmp_eq_u32 s80, 1
    s_cbranch_scc1 L_bw125
    s_waitcnt vmcnt(4)
    s_cmp_eq_u32 s80, 0
    s_cbranch_scc1 L_bw125
    s_waitcnt vmcnt(3)
L_bw125:
    buffer_load_dwordx4 v[88:91], v1, s[44:47], s8 offen offset:3072 nt
    v_mov_b32_dpp v15, v49 row_newbcast:7 row_mask:0xf bank_mask:0xf
    v_and_b32 v12, v15, v2
    v_and_b32 v13, v15, v3
    v_and_b32 v14, v15, v4
    v_and_b32 v15, v15, v5
    s_waitcnt vmcnt(6)
    v_mfma_f32_16x16x32_bf16 v[40:43], v[64:67], v[16:19], v[40:43]
    s_cmp_gt_i32 s81, 0
    s_cselect_b32 s80, 1, 0
    s_cmp_lt_i32 s81, 0
    s_cselect_b32 s9, 1, 0
    s_sub_u32 s81, s81, s80
    s_add_u32 s81, s81, s9
    s_lshl1_add_u32 s80, s9, s80
    s_cmp_eq_u32 s80, 1
    s_cbranch_scc1 L_bw126
    s_waitcnt vmcnt(4)
    s_cmp_eq_u32 s80, 0
    s_cbranch_scc1 L_bw126
    s_waitcnt vmcnt(3)
L_bw126:
    s_mov_b32 s8, 802816
    buffer_load_dwordx4 v[64:67], v1, s[44:47], s8 offen offset:0 nt
    v_mov_b32_dpp v19, v49 row_newbcast:15 row_mask:0xf bank_mask:0xf
    v_and_b32 v16, v19, v2
    v_and_b32 v17, v19, v3
    v_and_b32 v18, v19, v4
    v_and_b32 v19, v19, v5
    s_waitcnt vmcnt(6)
    v_mfma_f32_16x16x32_bf16 v[40:43], v[80:83], v[12:15], v[40:43]
    s_cmp_eq_u32 s80, 1
    s_cbranch_scc1 L_bw127
    s_waitcnt vmcnt(4)
    s_cmp_eq_u32 s80, 0
    s_cbranch_scc1 L_bw127
    s_waitcnt vmcnt(3)
L_bw127:
    buffer_load_dwordx4 v[80:83], v1, s[44:47], s8 offen offset:1024 nt
    v_mov_b32_dpp v15, v50 row_newbcast:0 row_mask:0xf bank_mask:0xf
    v_and_b32 v12, v15, v2
    v_and_b32 v13, v15, v3
    v_and_b32 v14, v15, v4
    v_and_b32 v15, v15, v5
    s_waitcnt vmcnt(6)
    v_mfma_f32_16x16x32_bf16 v[40:43], v[68:71], v[16:19], v[40:43]
    s_cmp_eq_u32 s80, 1
    s_cbranch_scc1 L_bw128
    s_waitcnt vmcnt(4)
    s_cmp_eq_u32 s80, 0
    s_cbranch_scc1 L_bw128
    s_waitcnt vmcnt(3)
L_bw128:
    buffer_load_dwordx4 v[68:71], v1, s[44:47], s8 offen offset:2048 nt
    v_mov_b32_dpp v19, v50 row_newbcast:8 row_mask:0xf bank_mask:0xf
    v_and_b32 v16, v19, v2
    v_and_b32 v17, v19, v3
    v_and_b32 v18, v19, v4
    v_and_b32 v19, v19, v5
    s_waitcnt vmcnt(6)
    v_mfma_f32_16x16x32_bf16 v[40:43], v[72:75], v[12:15], v[40:43]
    s_cmp_eq_u32 s80, 1
    s_cbranch_scc1 L_bw129
    s_waitcnt vmcnt(4)
    s_cmp_eq_u32 s80, 0
    s_cbranch_scc1 L_bw129
    s_waitcnt vmcnt(3)
L_bw129:
    buffer_load_dwordx4 v[72:75], v1, s[44:47], s8 offen offset:3072 nt
    v_mov_b32_dpp v15, v50 row_newbcast:4 row_mask:0xf bank_mask:0xf
    v_and_b32 v12, v15, v2
    v_and_b32 v13, v15, v3
    v_and_b32 v14, v15, v4
    v_and_b32 v15, v15, v5
    s_waitcnt vmcnt(6)
    v_mfma_f32_16x16x32_bf16 v[40:43], v[76:79], v[16:19], v[40:43]
    s_cmp_gt_i32 s81, 0
    s_cselect_b32 s80, 1, 0
    s_cmp_lt_i32 s81, 0
    s_cselect_b32 s9, 1, 0
    s_sub_u32 s81, s81, s80
    s_add_u32 s81, s81, s9
    s_lshl1_add_u32 s80, s9, s80
    s_cmp_eq_u32 s80, 1
    s_cbranch_scc1 L_bw130
    s_waitcnt vmcnt(4)
    s_cmp_eq_u32 s80, 0
    s_cbranch_scc1 L_bw130
    s_waitcnt vmcnt(3)
L_bw130:
    s_mov_b32 s8, 851968
    buffer_load_dwordx4 v[76:79], v1, s[44:47], s8 offen offset:0 nt
    v_mov_b32_dpp v19, v50 row_newbcast:12 row_mask:0xf bank_mask:0xf
    v_and_b32 v16, v19, v2
    v_and_b32 v17, v19, v3
    v_and_b32 v18, v19, v4
    v_and_b32 v19, v19, v5
    s_waitcnt vmcnt(6)
    v_mfma_f32_16x16x32_bf16 v[40:43], v[84:87], v[12:15], v[40:43]
    s_cmp_eq_u32 s80, 1
    s_cbranch_scc1 L_bw131
    s_waitcnt vmcnt(4)
    s_cmp_eq_u32 s80, 0
    s_cbranch_scc1 L_bw131
    s_waitcnt vmcnt(3)
L_bw131:
    buffer_load_dwordx4 v[84:87], v1, s[44:47], s8 offen offset:1024 nt
    v_mov_b32_dpp v15, v50 row_newbcast:2 row_mask:0xf bank_mask:0xf
    v_and_b32 v12, v15, v2
    v_and_b32 v13, v15, v3
    v_and_b32 v14, v15, v4
    v_and_b32 v15, v15, v5
    s_waitcnt vmcnt(6)
    v_mfma_f32_16x16x32_bf16 v[40:43], v[88:91], v[16:19], v[40:43]
    s_cmp_eq_u32 s80, 1
    s_cbranch_scc1 L_bw132
    s_waitcnt vmcnt(4)
    s_cmp_eq_u32 s80, 0
    s_cbranch_scc1 L_bw132
    s_waitcnt vmcnt(3)
L_bw132:
    buffer_load_dwordx4 v[88:91], v1, s[44:47], s8 offen offset:2048 nt
    v_mov_b32_dpp v19, v50 row_newbcast:10 row_mask:0xf bank_mask:0xf
    v_and_b32 v16, v19, v2
    v_and_b32 v17, v19, v3
    v_and_b32 v18, v19, v4
    v_and_b32 v19, v19, v5
    s_waitcnt vmcnt(6)
    v_mfma_f32_16x16x32_bf16 v[40:43], v[64:67], v[12:15], v[40:43]
    s_cmp_eq_u32 s80, 1
    s_cbranch_scc1 L_bw133
    s_waitcnt vmcnt(4)
    s_cmp_eq_u32 s80, 0
    s_cbranch_scc1 L_bw133
    s_waitcnt vmcnt(3)
L_bw133:
    buffer_load_dwordx4 v[64:67], v1, s[44:47], s8 offen offset:3072 nt
    buffer_load_ushort v55, v54, s[56:59], 0 offen
    buffer_load_ushort v59, v58, s[56:59], 0 offen
    v_mov_b32_dpp v15, v50 row_newbcast:6 row_mask:0xf bank_mask:0xf
    v_and_b32 v12, v15, v2
    v_and_b32 v13, v15, v3
    v_and_b32 v14, v15, v4
    v_and_b32 v15, v15, v5
    s_waitcnt vmcnt(8)
    v_mfma_f32_16x16x32_bf16 v[40:43], v[80:83], v[16:19], v[40:43]
    s_cmp_gt_i32 s81, 0
    s_cselect_b32 s80, 1, 0
    s_cmp_lt_i32 s81, 0
    s_cselect_b32 s9, 1, 0
    s_sub_u32 s81, s81, s80
    s_add_u32 s81, s81, s9
    s_lshl1_add_u32 s80, s9, s80
    s_cmp_eq_u32 s80, 1
    s_cbranch_scc1 L_bw134
    s_waitcnt vmcnt(6)
    s_cmp_eq_u32 s80, 0
    s_cbranch_scc1 L_bw134
    s_waitcnt vmcnt(5)
L_bw134:
    s_mov_b32 s8, 868352
    buffer_load_dwordx4 v[80:83], v1, s[44:47], s8 offen offset:0 nt
    v_mov_b32_dpp v19, v50 row_newbcast:14 row_mask:0xf bank_mask:0xf
    v_and_b32 v16, v19, v2
    v_and_b32 v17, v19, v3
    v_and_b32 v18, v19, v4
    v_and_b32 v19, v19, v5
    s_waitcnt vmcnt(8)
    v_mfma_f32_16x16x32_bf16 v[40:43], v[68:71], v[12:15], v[40:43]
    s_cmp_eq_u32 s80, 1
    s_cbranch_scc1 L_bw135
    s_waitcnt vmcnt(6)
    s_cmp_eq_u32 s80, 0
    s_cbranch_scc1 L_bw135
    s_waitcnt vmcnt(5)
L_bw135:
    buffer_load_dwordx4 v[68:71], v1, s[44:47], s8 offen offset:1024 nt
    v_mov_b32_dpp v15, v50 row_newbcast:1 row_mask:0xf bank_mask:0xf
    v_and_b32 v12, v15, v2
    v_and_b32 v13, v15, v3
    v_and_b32 v14, v15, v4
    v_and_b32 v15, v15, v5
    s_waitcnt vmcnt(8)
    v_mfma_f32_16x16x32_bf16 v[40:43], v[72:75], v[16:19], v[40:43]
    s_cmp_eq_u32 s80, 1
    s_cbranch_scc1 L_bw136
    s_waitcnt vmcnt(6)
    s_cmp_eq_u32 s80, 0
    s_cbranch_scc1 L_bw136
    s_waitcnt vmcnt(5)
L_bw136:
    buffer_load_dwordx4 v[72:75], v1, s[44:47], s8 offen offset:2048 nt
    v_mov_b32_dpp v19, v50 row_newbcast:9 row_mask:0xf bank_mask:0xf
    v_and_b32 v16, v19, v2
    v_and_b32 v17, v19, v3
    v_and_b32 v18, v19, v4
    v_and_b32 v19, v19, v5
    s_waitcnt vmcnt(8)
    v_mfma_f32_16x16x32_bf16 v[40:43], v[76:79], v[12:15], v[40:43]
    s_cmp_eq_u32 s80, 1
    s_cbranch_scc1 L_bw137
    s_waitcnt vmcnt(6)
    s_cmp_eq_u32 s80, 0
    s_cbranch_scc1 L_bw137
    s_waitcnt vmcnt(5)
L_bw137:
    buffer_load_dwordx4 v[76:79], v1, s[44:47], s8 offen offset:3072 nt
    v_mov_b32_dpp v15, v50 row_newbcast:5 row_mask:0xf bank_mask:0xf
    v_and_b32 v12, v15, v2
    v_and_b32 v13, v15, v3
    v_and_b32 v14, v15, v4
    v_and_b32 v15, v15, v5
    s_waitcnt vmcnt(8)
    v_mfma_f32_16x16x32_bf16 v[40:43], v[84:87], v[16:19], v[40:43]
    s_cmp_gt_i32 s81, 0
    s_cselect_b32 s80, 1, 0
    s_cmp_lt_i32 s81, 0
    s_cselect_b32 s9, 1, 0
    s_sub_u32 s81, s81, s80
    s_add_u32 s81, s81, s9
    s_lshl1_add_u32 s80, s9, s80
    s_cmp_eq_u32 s80, 1
    s_cbranch_scc1 L_bw138
    s_waitcnt vmcnt(6)
    s_cmp_eq_u32 s80, 0
    s_cbranch_scc1 L_bw138
    s_waitcnt vmcnt(3)
L_bw138:
    s_mov_b32 s8, 917504
    buffer_load_dwordx4 v[84:87], v1, s[44:47], s8 offen offset:0 nt
    v_mov_b32_dpp v19, v50 row_newbcast:13 row_mask:0xf bank_mask:0xf
    v_and_b32 v16, v19, v2
    v_and_b32 v17, v19, v3
    v_and_b32 v18, v19, v4
    v_and_b32 v19, v19, v5
    s_waitcnt vmcnt(8)
    v_mfma_f32_16x16x32_bf16 v[40:43], v[88:91], v[12:15], v[40:43]
    s_cmp_eq_u32 s80, 1
    s_cbranch_scc1 L_bw139
    s_waitcnt vmcnt(4)
    s_cmp_eq_u32 s80, 0
    s_cbranch_scc1 L_bw139
    s_waitcnt vmcnt(3)
L_bw139:
    buffer_load_dwordx4 v[88:91], v1, s[44:47], s8 offen offset:1024 nt
    v_mov_b32_dpp v15, v50 row_newbcast:3 row_mask:0xf bank_mask:0xf
    v_and_b32 v12, v15, v2
    v_and_b32 v13, v15, v3
    v_and_b32 v14, v15, v4
    v_and_b32 v15, v15, v5
    s_waitcnt vmcnt(8)
    v_mfma_f32_16x16x32_bf16 v[40:43], v[64:67], v[16:19], v[40:43]
    s_cmp_eq_u32 s80, 1
    s_cbranch_scc1 L_bw140
    s_waitcnt vmcnt(4)
    s_cmp_eq_u32 s80, 0
    s_cbranch_scc1 L_bw140
    s_waitcnt vmcnt(3)
L_bw140:
    buffer_load_dwordx4 v[64:67], v1, s[44:47], s8 offen offset:2048 nt
    v_mov_b32_dpp v19, v50 row_newbcast:11 row_mask:0xf bank_mask:0xf
    v_and_b32 v16, v19, v2
    v_and_b32 v17, v19, v3
    v_and_b32 v18, v19, v4
    v_and_b32 v19, v19, v5
    s_waitcnt vmcnt(6)
    v_mfma_f32_16x16x32_bf16 v[40:43], v[80:83], v[12:15], v[40:43]
    s_cmp_eq_u32 s80, 1
    s_cbranch_scc1 L_bw141
    s_waitcnt vmcnt(4)
    s_cmp_eq_u32 s80, 0
    s_cbranch_scc1 L_bw141
    s_waitcnt vmcnt(3)
L_bw141:
    buffer_load_dwordx4 v[80:83], v1, s[44:47], s8 offen offset:3072 nt
    s_mov_b32 s8, 933888
    buffer_load_dwordx4 v[92:95], v1, s[44:47], s8 offen offset:0 nt
    v_mov_b32_dpp v15, v50 row_newbcast:7 row_mask:0xf bank_mask:0xf
    v_and_b32 v12, v15, v2
    v_and_b32 v13, v15, v3
    v_and_b32 v14, v15, v4
    v_and_b32 v15, v15, v5
    s_waitcnt vmcnt(7)
    v_mfma_f32_16x16x32_bf16 v[40:43], v[68:71], v[16:19], v[40:43]
    buffer_load_dwordx4 v[68:71], v1, s[44:47], s8 offen offset:1024 nt
    v_mov_b32_dpp v19, v50 row_newbcast:15 row_mask:0xf bank_mask:0xf
    v_and_b32 v16, v19, v2
    v_and_b32 v17, v19, v3
    v_and_b32 v18, v19, v4
    v_and_b32 v19, v19, v5
    s_waitcnt vmcnt(7)
    v_mfma_f32_16x16x32_bf16 v[40:43], v[72:75], v[12:15], v[40:43]
    buffer_load_dwordx4 v[72:75], v1, s[44:47], s8 offen offset:2048 nt
    v_mov_b32_dpp v15, v51 row_newbcast:0 row_mask:0xf bank_mask:0xf
    v_and_b32 v12, v15, v2
    v_and_b32 v13, v15, v3
    v_and_b32 v14, v15, v4
    v_and_b32 v15, v15, v5
    s_waitcnt vmcnt(7)
    v_mfma_f32_16x16x32_bf16 v[40:43], v[76:79], v[16:19], v[40:43]
    buffer_load_dwordx4 v[76:79], v1, s[44:47], s8 offen offset:3072 nt
    v_mov_b32_dpp v19, v51 row_newbcast:8 row_mask:0xf bank_mask:0xf
    v_and_b32 v16, v19, v2
    v_and_b32 v17, v19, v3
    v_and_b32 v18, v19, v4
    v_and_b32 v19, v19, v5
    s_waitcnt vmcnt(7)
    v_mfma_f32_16x16x32_bf16 v[40:43], v[84:87], v[12:15], v[40:43]
    s_mov_b32 s8, 983040
    buffer_load_dwordx4 v[84:87], v1, s[44:47], s8 offen offset:0 nt
    s_lshl_b32 s9, s15, 2
    v_mov_b32 v20, s9
    s_mov_b32 s9, 0x2000000
L_sp142:
    ds_read_b32 v21, v8 offset:27476
    ds_read_b32 v60, v20 offset:26912
    s_waitcnt lgkmcnt(0)
    v_readfirstlane_b32 s10, v21
    s_nop 0
    s_cmp_ge_u32 s10, 1
    s_cbranch_scc1 L_spd143
    s_sub_u32 s9, s9, 1
    s_cmp_eq_u32 s9, 0
    s_cbranch_scc1 L_spd143
    s_sleep 2
    s_branch L_sp142
L_spd143:
    v_mov_b32_dpp v15, v51 row_newbcast:4 row_mask:0xf bank_mask:0xf
    v_and_b32 v12, v15, v2
    v_and_b32 v13, v15, v3
    v_and_b32 v14, v15, v4
    v_and_b32 v15, v15, v5
    s_waitcnt vmcnt(7)
    v_mfma_f32_16x16x32_bf16 v[40:43], v[88:91], v[16:19], v[40:43]
    buffer_load_dwordx4 v[88:91], v1, s[44:47], s8 offen offset:1024 nt
    v_mov_b32_dpp v19, v51 row_newbcast:12 row_mask:0xf bank_mask:0xf
    v_and_b32 v16, v19, v2
    v_and_b32 v17, v19, v3
    v_and_b32 v18, v19, v4
    v_and_b32 v19, v19, v5
    s_waitcnt vmcnt(7)
    v_mfma_f32_16x16x32_bf16 v[40:43], v[64:67], v[12:15], v[40:43]
    buffer_load_dwordx4 v[64:67], v1, s[44:47], s8 offen offset:2048 nt
    v_mov_b32_dpp v15, v51 row_newbcast:2 row_mask:0xf bank_mask:0xf
    v_and_b32 v12, v15, v2
    v_and_b32 v13, v15, v3
    v_and_b32 v14, v15, v4
    v_and_b32 v15, v15, v5
    s_waitcnt vmcnt(7)
    v_mfma_f32_16x16x32_bf16 v[40:43], v[80:83], v[16:19], v[40:43]
    buffer_load_dwordx4 v[80:83], v1, s[44:47], s8 offen offset:3072 nt
    v_mov_b32_dpp v19, v51 row_newbcast:10 row_mask:0xf bank_mask:0xf
    v_and_b32 v16, v19, v2
    v_and_b32 v17, v19, v3
    v_and_b32 v18, v19, v4
    v_and_b32 v19, v19, v5
    s_waitcnt vmcnt(7)
    v_mfma_f32_16x16x32_bf16 v[40:43], v[92:95], v[12:15], v[40:43]
    s_mov_b32 s8, 999424
    buffer_load_dwordx4 v[92:95], v1, s[44:47], s8 offen offset:0 nt
    v_mov_b32_dpp v15, v51 row_newbcast:6 row_mask:0xf bank_mask:0xf
    v_and_b32 v12, v15, v2
    v_and_b32 v13, v15, v3
    v_and_b32 v14, v15, v4
    v_and_b32 v15, v15, v5
    s_waitcnt vmcnt(7)
    v_mfma_f32_16x16x32_bf16 v[40:43], v[68:71], v[16:19], v[40:43]
    buffer_load_dwordx4 v[68:71], v1, s[44:47], s8 offen offset:1024 nt
    v_mov_b32_dpp v19, v51 row_newbcast:14 row_mask:0xf bank_mask:0xf
    v_and_b32 v16, v19, v2
    v_and_b32 v17, v19, v3
    v_and_b32 v18, v19, v4
    v_and_b32 v19, v19, v5
    s_waitcnt vmcnt(7)
    v_mfma_f32_16x16x32_bf16 v[40:43], v[72:75], v[12:15], v[40:43]
    buffer_load_dwordx4 v[72:75], v1, s[44:47], s8 offen offset:2048 nt
    v_mov_b32_dpp v15, v51 row_newbcast:1 row_mask:0xf bank_mask:0xf
    v_and_b32 v12, v15, v2
    v_and_b32 v13, v15, v3
    v_and_b32 v14, v15, v4
    v_and_b32 v15, v15, v5
    s_waitcnt vmcnt(7)
    v_mfma_f32_16x16x32_bf16 v[40:43], v[76:79], v[16:19], v[40:43]
    buffer_load_dwordx4 v[76:79], v1, s[44:47], s8 offen offset:3072 nt
    v_mov_b32_dpp v19, v51 row_newbcast:9 row_mask:0xf bank_mask:0xf
    v_and_b32 v16, v19, v2
    v_and_b32 v17, v19, v3
    v_and_b32 v18, v19, v4
    v_and_b32 v19, v19, v5
    s_waitcnt vmcnt(7)
    v_mfma_f32_16x16x32_bf16 v[40:43], v[84:87], v[12:15], v[40:43]
    v_mov_b32_dpp v15, v51 row_newbcast:5 row_mask:0xf bank_mask:0xf
    v_and_b32 v12, v15, v2
    v_and_b32 v13, v15, v3
    v_and_b32 v14, v15, v4
    v_and_b32 v15, v15, v5
    s_waitcnt vmcnt(6)
    v_mfma_f32_16x16x32_bf16 v[40:43], v[88:91], v[16:19], v[40:43]
    v_mov_b32_dpp v19, v51 row_newbcast:13 row_mask:0xf bank_mask:0xf
    v_and_b32 v16, v19, v2
    v_and_b32 v17, v19, v3
    v_and_b32 v18, v19, v4
    v_and_b32 v19, v19, v5
    s_waitcnt vmcnt(5)
    v_mfma_f32_16x16x32_bf16 v[40:43], v[64:67], v[12:15], v[40:43]
    v_mov_b32_dpp v15, v51 row_newbcast:3 row_mask:0xf bank_mask:0xf
    v_and_b32 v12, v15, v2
    v_and_b32 v13, v15, v3
    v_and_b32 v14, v15, v4
    v_and_b32 v15, v15, v5
    s_waitcnt vmcnt(4)
    v_mfma_f32_16x16x32_bf16 v[40:43], v[80:83], v[16:19], v[40:43]
    v_mov_b32_dpp v19, v51 row_newbcast:11 row_mask:0xf bank_mask:0xf
    v_and_b32 v16, v19, v2
    v_and_b32 v17, v19, v3
    v_and_b32 v18, v19, v4
    v_and_b32 v19, v19, v5
    s_waitcnt vmcnt(3)
    v_mfma_f32_16x16x32_bf16 v[40:43], v[92:95], v[12:15], v[40:43]
    v_mov_b32_dpp v15, v51 row_newbcast:7 row_mask:0xf bank_mask:0xf
    v_and_b32 v12, v15, v2
    v_and_b32 v13, v15, v3
    v_and_b32 v14, v15, v4
    v_and_b32 v15, v15, v5
    s_waitcnt vmcnt(2)
    v_mfma_f32_16x16x32_bf16 v[40:43], v[68:71], v[16:19], v[40:43]
    v_mov_b32_dpp v19, v51 row_newbcast:15 row_mask:0xf bank_mask:0xf
    v_and_b32 v16, v19, v2
    v_and_b32 v17, v19, v3
    v_and_b32 v18, v19, v4
    v_and_b32 v19, v19, v5
    s_waitcnt vmcnt(1)
    v_mfma_f32_16x16x32_bf16 v[40:43], v[72:75], v[12:15], v[40:43]
    s_waitcnt vmcnt(0)
    v_mfma_f32_16x16x32_bf16 v[40:43], v[76:79], v[16:19], v[40:43]
    s_mov_b32 exec_lo, 0x00ff00ff
    s_mov_b32 exec_hi, 0x00ff00ff
    s_nop 5
    v_mul_f32 v20, v40, v60
    v_mul_f32 v21, v41, v60
    v_mul_f32 v22, v42, v60
    v_mul_f32 v23, v43, v60
    ds_write_b128 v11, v[20:23] offset:28992
    s_mov_b64 exec, -1
    s_waitcnt lgkmcnt(0)
    s_barrier
    s_barrier
    v_add_u32 v72, 128, v52
    ds_read2st64_b32 v[64:65], v52 offset0:0 offset1:20
    ds_read2st64_b32 v[66:67], v52 offset0:40 offset1:60
    ds_read2st64_b32 v[68:69], v72 offset0:0 offset1:20
    ds_read2st64_b32 v[70:71], v72 offset0:40 offset1:60
    v_add_u32 v84, 128, v56
    ds_read2st64_b32 v[76:77], v56 offset0:0 offset1:20
    ds_read2st64_b32 v[78:79], v56 offset0:40 offset1:60
    ds_read2st64_b32 v[80:81], v84 offset0:0 offset1:20
    ds_read2st64_b32 v[82:83], v84 offset0:40 offset1:60
    s_waitcnt lgkmcnt(4)
    v_add_f32 v64, v64, v68
    v_add_f32 v65, v65, v69
    v_add_f32 v66, v66, v70
    v_add_f32 v67, v67, v71
    v_add_f32 v64, v64, v65
    v_add_f32 v66, v66, v67
    v_add_f32 v64, v64, v66
    v_cndmask_b32 v64, 1.0, v64, s[92:93]
    v_mov_b32 v65, v64
    buffer_atomic_add_f32 v65, v53, s[76:79], 0 offen sc0
    v_lshlrev_b32 v55, 16, v55
    v_add_f32 v64, v64, v55
    s_waitcnt lgkmcnt(0)
    v_add_f32 v76, v76, v80
    v_add_f32 v77, v77, v81
    v_add_f32 v78, v78, v82
    v_add_f32 v79, v79, v83
    v_add_f32 v76, v76, v77
    v_add_f32 v78, v78, v79
    v_add_f32 v76, v76, v78
    v_cndmask_b32 v76, 1.0, v76, s[94:95]
    v_mov_b32 v77, v76
    buffer_atomic_add_f32 v77, v57, s[76:79], 0 offen sc0
    v_lshlrev_b32 v59, 16, v59
    v_add_f32 v76, v76, v59
    s_waitcnt vmcnt(1)
    v_mov_b32_dpp v66, v65 row_newbcast:15 row_mask:0xf bank_mask:0xf
    v_add_f32 v64, v64, v65
    v_cmp_eq_f32 vcc, 0x427c0000, v66
    v_cvt_pk_bf16_f32 v64, v64, v64
    s_and_saveexec_b64 s[12:13], vcc
    s_cbranch_execz L_nf144
    buffer_store_short v64, v54, s[68:71], 0 offen
L_nf144:
    s_mov_b64 exec, -1
    s_waitcnt vmcnt(0)
    v_mov_b32_dpp v78, v77 row_newbcast:15 row_mask:0xf bank_mask:0xf
    v_add_f32 v76, v76, v77
    v_cmp_eq_f32 vcc, 0x427c0000, v78
    v_cvt_pk_bf16_f32 v76, v76, v76
    s_and_saveexec_b64 s[12:13], vcc
    s_cbranch_execz L_nf145
    buffer_store_short v76, v58, s[68:71], 0 offen
L_nf145:
    s_mov_b64 exec, -1
    s_endpgm
L_helper:
    s_cmp_eq_u32 s15, 3
    s_cbranch_scc0 L_nc146
    s_getpc_b64 s[72:73]
L_pc:
    s_sub_u32 s72, s72, L_pc-parallel_sum__mha_block_cached__swiglu_ffn__decode_kernel
    s_subb_u32 s73, s73, 0
    s_lshr_b32 s8, s2, 3
    s_lshl_b32 s8, s8, 10
    v_lshl_add_u32 v218, v20, 4, s8
    v_mov_b32 v217, s73
    v_add_co_u32 v216, vcc, s72, v218
    s_nop 1
    v_addc_co_u32 v217, vcc, 0, v217, vcc
    v_cmp_gt_u32 vcc, L_codeend-parallel_sum__mha_block_cached__swiglu_ffn__decode_kernel-16, v218
    s_nop 1
    s_and_saveexec_b64 s[74:75], vcc
    s_cbranch_execz L_nc146
    global_load_dwordx4 v[220:223], v[216:217], off
L_nc146:
    s_mov_b64 exec, -1
    v_lshlrev_b32 v26, 3, v0
    v_mov_b32 v9, 0
    ds_write_b64 v26, v[8:9] offset:26944
    v_and_b32 v21, 15, v0
    v_bfe_u32 v22, v0, 4, 2
    s_mul_i32 s9, s15, 1280
    v_lshl_add_u32 v6, v20, 4, s9
    v_lshl_add_u32 v7, v20, 2, s9
    s_lshr_b32 s11, s2, 5
    s_mul_i32 s12, s11, 80
    s_mul_i32 s13, s15, 20
    s_add_u32 s12, s12, s13
    s_lshl_b32 s10, s12, 13
    s_lshl_b32 s13, s4, 8
    s_add_u32 s10, s10, s13
    v_mul_u32_u24 v23, 40960, v22
    v_lshl_add_u32 v23, v21, 4, v23
    v_add_u32 v23, s10, v23
    s_and_b32 s13, s11, 3
    s_mul_i32 s13, s13, 160
    s_mul_i32 s14, s15, 40
    s_add_u32 s13, s13, s14
    s_mul_i32 s14, s7, 108
    s_mul_i32 s85, s13, 3456
    s_add_u32 s14, s14, s85
    v_lshrrev_b32 v24, 3, v20
    v_mul_u32_u24 v24, 3456, v24
    v_and_b32 v25, 7, v0
    v_lshl_add_u32 v24, v25, 4, v24
    v_add_u32 v24, s14, v24
    v_cmp_eq_u32 vcc, 7, v25
    v_mov_b32 v27, 0x7fff0000
    s_nop 0
    v_cndmask_b32 v24, v24, v27, vcc
    s_mov_b32 s47, s7
    s_lshl_b32 s7, s7, 1
    s_add_u32 s7, s7, s6
    s_mov_b32 s62, 2211840
    s_mov_b32 s63, 0x20000
    s_mov_b32 s58, 5120
    s_mov_b32 s59, 0x20000
    s_mov_b32 s50, 5242880
    s_mov_b32 s51, 0x20000
    s_waitcnt lgkmcnt(0)
    s_mov_b64 s[56:57], s[16:17]
    buffer_load_dwordx4 v[12:15], v6, s[56:59], 0 offen
    buffer_load_dword v16, v7, s[56:59], 0 offen offset:1024
    s_mov_b32 s9, 1835008
    s_load_dword s90, s[38:39], s9
    s_mov_b64 s[48:49], s[22:23]
    buffer_load_dwordx4 v[96:99], v23, s[48:51], 0 offen nt
    s_mov_b32 s8, 8192
    buffer_load_dwordx4 v[100:103], v23, s[48:51], s8 offen nt
    s_mov_b32 s8, 16384
    buffer_load_dwordx4 v[104:107], v23, s[48:51], s8 offen nt
    s_mov_b32 s8, 24576
    buffer_load_dwordx4 v[108:111], v23, s[48:51], s8 offen nt
    s_mov_b32 s8, 32768
    buffer_load_dwordx4 v[112:115], v23, s[48:51], s8 offen nt
    s_cmp_ge_u32 s11, 4
    s_cselect_b64 s[60:61], s[30:31], s[28:29]
    buffer_load_dwordx4 v[116:119], v24, s[60:63], 0 offen nt
    s_mov_b32 s8, 27648
    buffer_load_dwordx4 v[120:123], v24, s[60:63], s8 offen nt
    s_mov_b32 s8, 55296
    buffer_load_dwordx4 v[124:127], v24, s[60:63], s8 offen nt
    s_mov_b32 s8, 82944
    buffer_load_dwordx4 v[128:131], v24, s[60:63], s8 offen nt
    s_mov_b32 s8, 110592
    buffer_load_dwordx4 v[132:135], v24, s[60:63], s8 offen nt
    s_mov_b64 s[76:77], s[38:39]
    s_mov_b32 s78, 0x20000000
    s_mov_b32 s79, 0x20000
    s_mov_b64 s[68:69], s[34:35]
    s_mov_b32 s70, 0x1400
    s_mov_b32 s71, 0x20000
    s_mov_b64 s[52:53], s[24:25]
    s_mov_b32 s54, 0x500000
    s_mov_b32 s55, 0x20000
    s_mov_b64 s[64:65], s[32:33]
    s_mov_b32 s66, 0x21c000
    s_mov_b32 s67, 0x20000
    s_barrier
    v_and_b32 v26, 1, v0
    v_cmp_eq_u32 vcc, 1, v26
    v_mov_b32 v27, 0xffff
    v_mov_b32 v28, 0xffff0000
    v_cndmask_b32 v26, v27, v28, vcc
    v_bfe_u32 v27, v0, 1, 2
    v_cmp_eq_u32 vcc, 0, v27
    s_nop 1
    v_cndmask_b32 v2, 0, v26, vcc
    v_cmp_eq_u32 vcc, 1, v27
    s_nop 1
    v_cndmask_b32 v3, 0, v26, vcc
    v_cmp_eq_u32 vcc, 2, v27
    s_nop 1
    v_cndmask_b32 v4, 0, v26, vcc
    v_cmp_eq_u32 vcc, 3, v27
    s_nop 1
    v_cndmask_b32 v5, 0, v26, vcc
    v_lshlrev_b32 v69, 5, v20
    s_mul_i32 s9, s15, 2560
    v_add_u32 v69, s9, v69
    v_lshlrev_b32 v70, 3, v20
    v_add_u32 v70, s9, v70
    s_mov_b32 s10, 0x44200000
    s_mov_b32 s14, 0x3acccccd
    v_bfe_u32 v6, v0, 3, 1
    v_mul_u32_u24 v6, 2560, v6
    v_mul_u32_u24 v7, 20, v22
    s_lshl_b32 s9, s12, 2
    v_add3_u32 v6, v6, v7, s9
    v_lshrrev_b32 v7, 3, v20
    s_lshl_b32 s9, s13, 2
    v_lshl_add_u32 v7, v7, 2, s9
    v_mov_b32 v34, v7
    s_waitcnt vmcnt(10)
    v_lshlrev_b32 v56, 16, v12
    v_and_b32 v57, 0xffff0000, v12
    v_lshlrev_b32 v58, 16, v13
    v_and_b32 v59, 0xffff0000, v13
    v_lshlrev_b32 v60, 16, v14
    v_and_b32 v61, 0xffff0000, v14
    v_lshlrev_b32 v62, 16, v15
    v_and_b32 v63, 0xffff0000, v15
    v_lshlrev_b32 v64, 16, v16
    v_and_b32 v65, 0xffff0000, v16
    v_add_f32 v66, v56, v57
    v_add_f32 v67, v58, v59
    v_add_f32 v66, v66, v60
    v_add_f32 v67, v67, v61
    v_add_f32 v66, v66, v62
    v_add_f32 v67, v67, v63
    v_add_f32 v66, v66, v64
    v_add_f32 v67, v67, v65
    v_add_f32 v66, v66, v67
    s_nop 1
    v_add_f32_dpp v66, v66, v66 row_ror:8 row_mask:0xf bank_mask:0xf
    s_nop 1
    v_add_f32_dpp v66, v66, v66 row_ror:4 row_mask:0xf bank_mask:0xf
    s_nop 1
    v_add_f32_dpp v66, v66, v66 row_ror:2 row_mask:0xf bank_mask:0xf
    s_nop 1
    v_add_f32_dpp v66, v66, v66 row_ror:1 row_mask:0xf bank_mask:0xf
    s_nop 1
    v_add_f32_dpp v66, v66, v66 row_bcast:15 row_mask:0xa bank_mask:0xf
    s_nop 1
    v_add_f32_dpp v66, v66, v66 row_bcast:31 row_mask:0xc bank_mask:0xf
    s_nop 0
    v_readlane_b32 s9, v66, 63
    s_nop 1
    v_mov_b32 v67, s9
    v_mul_f32 v68, s14, v67
    v_fma_f32 v67, -v68, s10, v67
    v_fma_f32 v68, v67, s14, v68
    v_sub_f32 v12, v56, v68
    v_sub_f32 v13, v57, v68
    v_mul_f32 v66, v12, v12
    v_mul_f32 v67, v13, v13
    v_sub_f32 v12, v58, v68
    v_sub_f32 v13, v59, v68
    v_fmac_f32 v66, v12, v12
    v_fmac_f32 v67, v13, v13
    v_sub_f32 v12, v60, v68
    v_sub_f32 v13, v61, v68
    v_fmac_f32 v66, v12, v12
    v_fmac_f32 v67, v13, v13
    v_sub_f32 v12, v62, v68
    v_sub_f32 v13, v63, v68
    v_fmac_f32 v66, v12, v12
    v_fmac_f32 v67, v13, v13
    v_sub_f32 v12, v64, v68
    v_sub_f32 v13, v65, v68
    v_fmac_f32 v66, v12, v12
    v_fmac_f32 v67, v13, v13
    v_add_f32 v66, v66, v67
    s_nop 1
    v_add_f32_dpp v66, v66, v66 row_ror:8 row_mask:0xf bank_mask:0xf
    s_nop 1
    v_add_f32_dpp v66, v66, v66 row_ror:4 row_mask:0xf bank_mask:0xf
    s_nop 1
    v_add_f32_dpp v66, v66, v66 row_ror:2 row_mask:0xf bank_mask:0xf
    s_nop 1
    v_add_f32_dpp v66, v66, v66 row_ror:1 row_mask:0xf bank_mask:0xf
    s_nop 1
    v_add_f32_dpp v66, v66, v66 row_bcast:15 row_mask:0xa bank_mask:0xf
    s_nop 1
    v_add_f32_dpp v66, v66, v66 row_bcast:31 row_mask:0xc bank_mask:0xf
    s_nop 0
    v_readlane_b32 s9, v66, 63
    s_nop 1
    v_mov_b32 v67, s9
    v_mul_f32 v66, s14, v67
    v_fma_f32 v67, -v66, s10, v67
    v_fma_f32 v66, v67, s14, v66
    v_cvt_pk_bf16_f32 v67, v68, v66
    v_lshlrev_b32 v68, 16, v67
    v_and_b32 v66, 0xffff0000, v67
    v_add_f32 v66, 0x3727c5ac, v66
    v_cvt_pk_bf16_f32 v66, v66, v66
    v_and_b32 v66, 0xffff0000, v66
    v_sqrt_f32 v66, v66
    s_nop 0
    v_cvt_pk_bf16_f32 v66, v66, v66
    v_and_b32 v66, 0xffff0000, v66
    v_rcp_f32 v66, v66
    v_sub_f32 v56, v56, v68
    v_sub_f32 v57, v57, v68
    v_cvt_pk_bf16_f32 v67, v56, v57
    v_lshlrev_b32 v56, 16, v67
    v_and_b32 v57, 0xffff0000, v67
    v_mul_f32 v56, v56, v66
    v_mul_f32 v57, v57, v66
    v_cvt_pk_bf16_f32 v56, v56, v56
    v_cvt_pk_bf16_f32 v57, v57, v57
    v_sub_f32 v58, v58, v68
    v_sub_f32 v59, v59, v68
    v_cvt_pk_bf16_f32 v67, v58, v59
    v_lshlrev_b32 v58, 16, v67
    v_and_b32 v59, 0xffff0000, v67
    v_mul_f32 v58, v58, v66
    v_mul_f32 v59, v59, v66
    v_cvt_pk_bf16_f32 v58, v58, v58
    v_cvt_pk_bf16_f32 v59, v59, v59
    v_sub_f32 v60, v60, v68
    v_sub_f32 v61, v61, v68
    v_cvt_pk_bf16_f32 v67, v60, v61
    v_lshlrev_b32 v60, 16, v67
    v_and_b32 v61, 0xffff0000, v67
    v_mul_f32 v60, v60, v66
    v_mul_f32 v61, v61, v66
    v_cvt_pk_bf16_f32 v60, v60, v60
    v_cvt_pk_bf16_f32 v61, v61, v61
    v_sub_f32 v62, v62, v68
    v_sub_f32 v63, v63, v68
    v_cvt_pk_bf16_f32 v67, v62, v63
    v_lshlrev_b32 v62, 16, v67
    v_and_b32 v63, 0xffff0000, v67
    v_mul_f32 v62, v62, v66
    v_mul_f32 v63, v63, v66
    v_cvt_pk_bf16_f32 v62, v62, v62
    v_cvt_pk_bf16_f32 v63, v63, v63
    v_sub_f32 v64, v64, v68
    v_sub_f32 v65, v65, v68
    v_cvt_pk_bf16_f32 v67, v64, v65
    v_lshlrev_b32 v64, 16, v67
    v_and_b32 v65, 0xffff0000, v67
    v_mul_f32 v64, v64, v66
    v_mul_f32 v65, v65, v66
    v_cvt_pk_bf16_f32 v64, v64, v64
    v_cvt_pk_bf16_f32 v65, v65, v65
    v_mov_b32 v67, 1
    ds_write_b128 v69, v[56:59] offset:0
    ds_write_b128 v69, v[60:63] offset:16
    ds_write_b64 v70, v[64:65] offset:2048
    s_mov_b64 exec, 1
    ds_add_u32 v8, v67 offset:27456
    s_mov_b64 exec, -1
    v_lshl_add_u32 v31, v22, 3, v25
    v_lshlrev_b32 v31, 4, v31
    v_bfe_u32 v30, v0, 3, 1
    v_lshl_add_u32 v31, v30, 9, v31
    s_lshl_b32 s85, s15, 11
    v_add_u32 v31, s85, v31
    v_lshlrev_b32 v30, 4, v20
    v_lshlrev_b32 v32, 3, v0
    s_mul_i32 s9, s7, 34560
    s_lshl_b32 s10, s5, 2
    s_add_u32 s10, s10, s15
    s_mul_i32 s10, s10, 2160
    s_add_u32 s9, s9, s10
    buffer_load_dwordx4 v[224:227], v30, s[64:67], s9 offen offset:0
    buffer_load_dwordx4 v[228:231], v30, s[64:67], s9 offen offset:1024
    s_mov_b32 exec_lo, 0x0000007f
    s_mov_b32 exec_hi, 0x00000000
    buffer_load_dwordx4 v[232:235], v30, s[64:67], s9 offen offset:2048
    s_mov_b64 exec, -1
    s_mul_i32 s9, s4, 163840
    s_mul_i32 s10, s11, 20480
    s_add_u32 s9, s9, s10
    s_mul_i32 s10, s15, 5120
    s_add_u32 s9, s9, s10
    buffer_load_dwordx4 v[236:239], v30, s[52:55], s9 offen offset:0
    buffer_load_dwordx4 v[240:243], v30, s[52:55], s9 offen offset:1024
    buffer_load_dwordx4 v[244:247], v30, s[52:55], s9 offen offset:2048
    buffer_load_dwordx4 v[248:251], v30, s[52:55], s9 offen offset:3072
    s_add_u32 s9, s9, 4096
    buffer_load_dwordx4 v[252:255], v30, s[52:55], s9 offen offset:0
    s_mov_b32 s9, 0x2000000
L_sp147:
    ds_read_b32 v29, v8 offset:27456
    ds_read_b32 v160, v6 offset:0
    ds_read_b32 v161, v6 offset:4
    ds_read_b32 v162, v6 offset:8
    ds_read_b32 v163, v6 offset:12
    ds_read_b32 v164, v6 offset:16
    ds_read_b32 v165, v6 offset:5120
    ds_read_b32 v166, v6 offset:5124
    ds_read_b32 v167, v6 offset:5128
    ds_read_b32 v168, v6 offset:5132
    ds_read_b32 v169, v6 offset:5136
    s_waitcnt lgkmcnt(0)
    v_readfirstlane_b32 s10, v29
    s_nop 0
    s_cmp_ge_u32 s10, 4
    s_cbranch_scc1 L_spd148
    s_sub_u32 s9, s9, 1
    s_cmp_eq_u32 s9, 0
    s_cbranch_scc1 L_spd148
    s_sleep 1
    s_branch L_sp147
L_spd148:
    s_mul_i32 s90, s90, 1664525
    s_add_u32 s90, s90, 1013904223
    s_getreg_b32 s82, hwreg(HW_REG_XCC_ID, 0, 4)
    s_and_b32 s83, s90, -16
    s_or_b32 s83, s83, s82
    v_and_b32 v12, v160, v2
    v_and_b32 v13, v160, v3
    v_and_b32 v14, v160, v4
    v_and_b32 v15, v160, v5
    v_and_b32 v16, v165, v2
    v_and_b32 v17, v165, v3
    v_and_b32 v18, v165, v4
    v_and_b32 v19, v165, v5
    s_waitcnt vmcnt(17)
    v_mfma_f32_16x16x32_bf16 v[136:139], v[96:99], v[12:15], 0
    v_and_b32 v12, v161, v2
    v_and_b32 v13, v161, v3
    v_and_b32 v14, v161, v4
    v_and_b32 v15, v161, v5
    v_mfma_f32_16x16x32_bf16 v[140:143], v[96:99], v[16:19], 0
    v_and_b32 v16, v166, v2
    v_and_b32 v17, v166, v3
    v_and_b32 v18, v166, v4
    v_and_b32 v19, v166, v5
    s_waitcnt vmcnt(16)
    v_mfma_f32_16x16x32_bf16 v[136:139], v[100:103], v[12:15], v[136:139]
    v_and_b32 v12, v162, v2
    v_and_b32 v13, v162, v3
    v_and_b32 v14, v162, v4
    v_and_b32 v15, v162, v5
    v_mfma_f32_16x16x32_bf16 v[140:143], v[100:103], v[16:19], v[140:143]
    v_and_b32 v16, v167, v2
    v_and_b32 v17, v167, v3
    v_and_b32 v18, v167, v4
    v_and_b32 v19, v167, v5
    s_waitcnt vmcnt(15)
    v_mfma_f32_16x16x32_bf16 v[136:139], v[104:107], v[12:15], v[136:139]
    v_and_b32 v12, v163, v2
    v_and_b32 v13, v163, v3
    v_and_b32 v14, v163, v4
    v_and_b32 v15, v163, v5
    v_mfma_f32_16x16x32_bf16 v[140:143], v[104:107], v[16:19], v[140:143]
    v_and_b32 v16, v168, v2
    v_and_b32 v17, v168, v3
    v_and_b32 v18, v168, v4
    v_and_b32 v19, v168, v5
    s_waitcnt vmcnt(14)
    v_mfma_f32_16x16x32_bf16 v[136:139], v[108:111], v[12:15], v[136:139]
    v_and_b32 v12, v164, v2
    v_and_b32 v13, v164, v3
    v_and_b32 v14, v164, v4
    v_and_b32 v15, v164, v5
    v_mfma_f32_16x16x32_bf16 v[140:143], v[108:111], v[16:19], v[140:143]
    v_and_b32 v16, v169, v2
    v_and_b32 v17, v169, v3
    v_and_b32 v18, v169, v4
    v_and_b32 v19, v169, v5
    s_waitcnt vmcnt(13)
    v_mfma_f32_16x16x32_bf16 v[136:139], v[112:115], v[12:15], v[136:139]
    v_mfma_f32_16x16x32_bf16 v[140:143], v[112:115], v[16:19], v[140:143]
    ds_read_b32 v172, v7 offset:0
    ds_read_b32 v173, v7 offset:32
    ds_read_b32 v174, v7 offset:64
    ds_read_b32 v175, v7 offset:96
    ds_read_b32 v176, v7 offset:128
    ds_read_b32 v177, v7 offset:2560
    ds_read_b32 v178, v7 offset:2592
    ds_read_b32 v179, v7 offset:2624
    ds_read_b32 v180, v7 offset:2656
    ds_read_b32 v181, v7 offset:2688
    v_mov_b32 v29, 1
    ds_write_b128 v31, v[136:139] offset:10240
    ds_write_b128 v31, v[140:143] offset:11264
    s_mov_b64 exec, 1
    ds_add_u32 v8, v29 offset:27480
    s_mov_b64 exec, -1
    s_lshl_b32 s81, s47, 5
    s_add_u32 s81, s81, s11
    s_lshl_b32 s81, s81, 10
    s_add_u32 s81, s81, 786432
    s_lshl_b32 s8, s15, 13
    s_add_u32 s8, s8, s81
    s_waitcnt lgkmcnt(0)
    s_mov_b32 s9, 0x2000000
L_sp149:
    ds_read_b32 v29, v8 offset:27480
    ds_read_b64 v[160:161], v32 offset:10240
    ds_read_b64 v[162:163], v32 offset:12288
    ds_read_b64 v[164:165], v32 offset:14336
    ds_read_b64 v[166:167], v32 offset:16384
    s_waitcnt lgkmcnt(0)
    v_readfirstlane_b32 s10, v29
    s_nop 0
    s_cmp_ge_u32 s10, 4
    s_cbranch_scc1 L_spd150
    s_sub_u32 s9, s9, 1
    s_cmp_eq_u32 s9, 0
    s_cbranch_scc1 L_spd150
    s_sleep 1
    s_branch L_sp149
L_spd150:
    v_add_f32 v160, v160, v162
    v_add_f32 v161, v161, v163
    v_add_f32 v164, v164, v166
    v_add_f32 v165, v165, v167
    v_add_f32 v136, v160, v164
    v_add_f32 v138, v161, v165
    v_mov_b32 v137, s83
    v_mov_b32 v139, s83
    buffer_store_dwordx4 v[136:139], v30, s[76:79], s8 offen
    ds_read_b32 v182, v34 offset:5120
    ds_read_b32 v183, v34 offset:5152
    ds_read_b32 v184, v34 offset:5184
    ds_read_b32 v185, v34 offset:5216
    ds_read_b32 v186, v34 offset:5248
    ds_read_b32 v187, v34 offset:7680
    ds_read_b32 v188, v34 offset:7712
    ds_read_b32 v189, v34 offset:7744
    ds_read_b32 v190, v34 offset:7776
    ds_read_b32 v191, v34 offset:7808
    s_waitcnt lgkmcnt(0)
    v_and_b32 v12, v172, v2
    v_and_b32 v13, v172, v3
    v_and_b32 v14, v172, v4
    v_and_b32 v15, v172, v5
    v_and_b32 v16, v177, v2
    v_and_b32 v17, v177, v3
    v_and_b32 v18, v177, v4
    v_and_b32 v19, v177, v5
    s_waitcnt vmcnt(13)
    v_mfma_f32_16x16x32_bf16 v[144:147], v[116:119], v[12:15], 0
    v_and_b32 v12, v182, v2
    v_and_b32 v13, v182, v3
    v_and_b32 v14, v182, v4
    v_and_b32 v15, v182, v5
    v_mfma_f32_16x16x32_bf16 v[148:151], v[116:119], v[16:19], 0
    v_and_b32 v16, v187, v2
    v_and_b32 v17, v187, v3
    v_and_b32 v18, v187, v4
    v_and_b32 v19, v187, v5
    v_mfma_f32_16x16x32_bf16 v[152:155], v[116:119], v[12:15], 0
    v_and_b32 v12, v173, v2
    v_and_b32 v13, v173, v3
    v_and_b32 v14, v173, v4
    v_and_b32 v15, v173, v5
    v_mfma_f32_16x16x32_bf16 v[156:159], v[116:119], v[16:19], 0
    v_and_b32 v16, v178, v2
    v_and_b32 v17, v178, v3
    v_and_b32 v18, v178, v4
    v_and_b32 v19, v178, v5
    s_waitcnt vmcnt(12)
    v_mfma_f32_16x16x32_bf16 v[144:147], v[120:123], v[12:15], v[144:147]
    v_and_b32 v12, v183, v2
    v_and_b32 v13, v183, v3
    v_and_b32 v14, v183, v4
    v_and_b32 v15, v183, v5
    v_mfma_f32_16x16x32_bf16 v[148:151], v[120:123], v[16:19], v[148:151]
    v_and_b32 v16, v188, v2
    v_and_b32 v17, v188, v3
    v_and_b32 v18, v188, v4
    v_and_b32 v19, v188, v5
    v_mfma_f32_16x16x32_bf16 v[152:155], v[120:123], v[12:15], v[152:155]
    v_and_b32 v12, v174, v2
    v_and_b32 v13, v174, v3
    v_and_b32 v14, v174, v4
    v_and_b32 v15, v174, v5
    v_mfma_f32_16x16x32_bf16 v[156:159], v[120:123], v[16:19], v[156:159]
    v_and_b32 v16, v179, v2
    v_and_b32 v17, v179, v3
    v_and_b32 v18, v179, v4
    v_and_b32 v19, v179, v5
    s_waitcnt vmcnt(11)
    v_mfma_f32_16x16x32_bf16 v[144:147], v[124:127], v[12:15], v[144:147]
    v_and_b32 v12, v184, v2
    v_and_b32 v13, v184, v3
    v_and_b32 v14, v184, v4
    v_and_b32 v15, v184, v5
    v_mfma_f32_16x16x32_bf16 v[148:151], v[124:127], v[16:19], v[148:151]
    v_and_b32 v16, v189, v2
    v_and_b32 v17, v189, v3
    v_and_b32 v18, v189, v4
    v_and_b32 v19, v189, v5
    v_mfma_f32_16x16x32_bf16 v[152:155], v[124:127], v[12:15], v[152:155]
    v_and_b32 v12, v175, v2
    v_and_b32 v13, v175, v3
    v_and_b32 v14, v175, v4
    v_and_b32 v15, v175, v5
    v_mfma_f32_16x16x32_bf16 v[156:159], v[124:127], v[16:19], v[156:159]
    v_and_b32 v16, v180, v2
    v_and_b32 v17, v180, v3
    v_and_b32 v18, v180, v4
    v_and_b32 v19, v180, v5
    s_waitcnt vmcnt(10)
    v_mfma_f32_16x16x32_bf16 v[144:147], v[128:131], v[12:15], v[144:147]
    v_and_b32 v12, v185, v2
    v_and_b32 v13, v185, v3
    v_and_b32 v14, v185, v4
    v_and_b32 v15, v185, v5
    v_mfma_f32_16x16x32_bf16 v[148:151], v[128:131], v[16:19], v[148:151]
    v_and_b32 v16, v190, v2
    v_and_b32 v17, v190, v3
    v_and_b32 v18, v190, v4
    v_and_b32 v19, v190, v5
    v_mfma_f32_16x16x32_bf16 v[152:155], v[128:131], v[12:15], v[152:155]
    v_and_b32 v12, v176, v2
    v_and_b32 v13, v176, v3
    v_and_b32 v14, v176, v4
    v_and_b32 v15, v176, v5
    v_mfma_f32_16x16x32_bf16 v[156:159], v[128:131], v[16:19], v[156:159]
    v_and_b32 v16, v181, v2
    v_and_b32 v17, v181, v3
    v_and_b32 v18, v181, v4
    v_and_b32 v19, v181, v5
    s_waitcnt vmcnt(9)
    v_mfma_f32_16x16x32_bf16 v[144:147], v[132:135], v[12:15], v[144:147]
    v_and_b32 v12, v186, v2
    v_and_b32 v13, v186, v3
    v_and_b32 v14, v186, v4
    v_and_b32 v15, v186, v5
    v_mfma_f32_16x16x32_bf16 v[148:151], v[132:135], v[16:19], v[148:151]
    v_and_b32 v16, v191, v2
    v_and_b32 v17, v191, v3
    v_and_b32 v18, v191, v4
    v_and_b32 v19, v191, v5
    v_mfma_f32_16x16x32_bf16 v[152:155], v[132:135], v[12:15], v[152:155]
    s_nop 0
    v_mfma_f32_16x16x32_bf16 v[156:159], v[132:135], v[16:19], v[156:159]
    v_bfe_u32 v7, v0, 4, 1
    v_lshl_add_u32 v6, v7, 3, v25
    v_lshlrev_b32 v6, 4, v6
    v_bfe_u32 v7, v0, 5, 1
    v_lshl_add_u32 v6, v7, 10, v6
    v_add_u32 v6, s85, v6
    s_mov_b32 exec_lo, 0x00ff00ff
    s_mov_b32 exec_hi, 0xff00ff00
    ds_write_b128 v6, v[144:147] offset:18688
    ds_write_b128 v6, v[148:151] offset:18944
    ds_write_b128 v6, v[152:155] offset:19200
    ds_write_b128 v6, v[156:159] offset:19456
    s_mov_b64 exec, -1
    v_lshlrev_b32 v23, 4, v21
    v_mul_u32_u24 v24, 1280, v22
    v_add_u32 v23, v23, v24
    s_mul_i32 s9, s7, 27
    s_lshl_b32 s10, s15, 3
    s_add_u32 s9, s9, s10
    s_mul_i32 s9, s9, 1280
    v_add_u32 v24, s9, v23
    v_add_u32 v28, s10, v22
    v_cmp_lt_u32 vcc, 26, v28
    v_mov_b32 v29, 0x7fff0000
    s_nop 0
    v_cndmask_b32 v24, v24, v29, vcc
    s_cmp_eq_u32 s15, 3
    s_cselect_b32 s45, 0x7fff0000, 0
    s_add_u32 s45, s45, 5120
    s_lshl_b32 s9, s4, 7
    s_lshl_b32 s10, s15, 5
    s_add_u32 s9, s9, s10
    s_mul_i32 s9, s9, 1280
    v_add_u32 v23, s9, v23
    s_mov_b32 s9, 0
    s_add_u32 s10, s9, 0
    s_cmp_ge_u32 s10, 5
    s_cselect_b32 s40, 5, 0
    s_sub_u32 s40, s10, s40
    s_lshl_b32 s40, s40, 8
    s_add_u32 s10, s9, 1
    s_cmp_ge_u32 s10, 5
    s_cselect_b32 s41, 5, 0
    s_sub_u32 s41, s10, s41
    s_lshl_b32 s41, s41, 8
    s_add_u32 s10, s9, 2
    s_cmp_ge_u32 s10, 5
    s_cselect_b32 s42, 5, 0
    s_sub_u32 s42, s10, s42
    s_lshl_b32 s42, s42, 8
    s_add_u32 s10, s9, 3
    s_cmp_ge_u32 s10, 5
    s_cselect_b32 s43, 5, 0
    s_sub_u32 s43, s10, s43
    s_lshl_b32 s43, s43, 8
    s_add_u32 s10, s9, 4
    s_cmp_ge_u32 s10, 5
    s_cselect_b32 s44, 5, 0
    s_sub_u32 s44, s10, s44
    s_lshl_b32 s44, s44, 8
    buffer_load_dwordx4 v[56:59], v24, s[64:67], s40 offen nt
    buffer_load_dwordx4 v[60:63], v24, s[64:67], s41 offen nt
    s_lshl_b32 s8, s47, 2
    s_add_u32 s8, s8, s5
    s_lshl_b32 s8, s8, 13
    s_add_u32 s8, s8, s85
    s_add_u32 s8, s8, 786432
    s_mov_b32 s9, 0x40000
    s_mov_b32 s80, 0
L_qpoll:
    buffer_load_dwordx4 v[96:99], v30, s[76:79], s8 offen offset:0 sc1
    buffer_load_dwordx4 v[100:103], v30, s[76:79], s8 offen offset:1024 sc1
L_qchk:
    s_waitcnt vmcnt(0)
    v_xor_b32 v97, s83, v97
    v_xor_b32 v99, s83, v99
    v_xor_b32 v101, s83, v101
    v_xor_b32 v103, s83, v103
    v_or3_b32 v97, v97, v99, v101
    v_or_b32 v97, v97, v103
    v_cmp_ne_u32 vcc, 0, v97
    s_sub_u32 s9, s9, 1
    s_nop 3
    s_cbranch_vccz L_qok
    v_cmp_lt_u32 s[86:87], 15, v97
    s_cmp_eq_u32 s80, 1
    s_cbranch_scc1 L_wtdone
    s_nop 3
    s_cmp_eq_u64 s[86:87], 0
    s_cbranch_scc1 L_wt
    s_cmp_gt_u32 s9, 262140
    s_cbranch_scc1 L_wtdone
L_wt:
    s_mov_b32 s80, 1
    v_mov_b32 v29, 1
    ds_write_b32 v8, v29 offset:27488
    v_lshlrev_b32 v33, 3, v20
    ds_read_b64 v[160:161], v33 offset:10240
    ds_read_b64 v[162:163], v33 offset:12288
    ds_read_b64 v[164:165], v33 offset:14336
    ds_read_b64 v[166:167], v33 offset:16384
    s_add_u32 s10, s81, 0
    s_waitcnt lgkmcnt(0)
    v_add_f32 v160, v160, v162
    v_add_f32 v161, v161, v163
    v_add_f32 v164, v164, v166
    v_add_f32 v165, v165, v167
    v_add_f32 v136, v160, v164
    v_add_f32 v138, v161, v165
    v_mov_b32 v137, s83
    v_mov_b32 v139, s83
    buffer_store_dwordx4 v[136:139], v30, s[76:79], s10 offen sc1
    s_nop 1
    ds_read_b64 v[160:161], v33 offset:10752
    ds_read_b64 v[162:163], v33 offset:12800
    ds_read_b64 v[164:165], v33 offset:14848
    ds_read_b64 v[166:167], v33 offset:16896
    s_add_u32 s10, s81, 8192
    s_waitcnt lgkmcnt(0)
    v_add_f32 v160, v160, v162
    v_add_f32 v161, v161, v163
    v_add_f32 v164, v164, v166
    v_add_f32 v165, v165, v167
    v_add_f32 v136, v160, v164
    v_add_f32 v138, v161, v165
    v_mov_b32 v137, s83
    v_mov_b32 v139, s83
    buffer_store_dwordx4 v[136:139], v30, s[76:79], s10 offen sc1
    s_nop 1
    ds_read_b64 v[160:161], v33 offset:11264
    ds_read_b64 v[162:163], v33 offset:13312
    ds_read_b64 v[164:165], v33 offset:15360
    ds_read_b64 v[166:167], v33 offset:17408
    s_add_u32 s10, s81, 16384
    s_waitcnt lgkmcnt(0)
    v_add_f32 v160, v160, v162
    v_add_f32 v161, v161, v163
    v_add_f32 v164, v164, v166
    v_add_f32 v165, v165, v167
    v_add_f32 v136, v160, v164
    v_add_f32 v138, v161, v165
    v_mov_b32 v137, s83
    v_mov_b32 v139, s83
    buffer_store_dwordx4 v[136:139], v30, s[76:79], s10 offen sc1
    s_nop 1
    ds_read_b64 v[160:161], v33 offset:11776
    ds_read_b64 v[162:163], v33 offset:13824
    ds_read_b64 v[164:165], v33 offset:15872
    ds_read_b64 v[166:167], v33 offset:17920
    s_add_u32 s10, s81, 24576
    s_waitcnt lgkmcnt(0)
    v_add_f32 v160, v160, v162
    v_add_f32 v161, v161, v163
    v_add_f32 v164, v164, v166
    v_add_f32 v165, v165, v167
    v_add_f32 v136, v160, v164
    v_add_f32 v138, v161, v165
    v_mov_b32 v137, s83
    v_mov_b32 v139, s83
    buffer_store_dwordx4 v[136:139], v30, s[76:79], s10 offen sc1
    s_nop 1
L_wtdone:
    s_nop 4
    s_cmp_eq_u64 s[86:87], 0
    s_cbranch_scc1 L_qok
    s_cmp_eq_u32 s9, 0
    s_cbranch_scc1 L_qok
    s_sleep 4
    s_branch L_qpoll
L_qok:
    v_add_f32 v96, v96, v100
    v_add_f32 v97, v98, v102
    ds_write_b64 v32, v[96:97] offset:31040
    v_mov_b32 v29, 1
    s_mov_b64 exec, 1
    ds_add_rtn_u32 v29, v8, v29 offset:27484
    s_mov_b64 exec, -1
    s_waitcnt lgkmcnt(0)
    v_readfirstlane_b32 s9, v29
    s_nop 0
    s_cmp_eq_u32 s9, 3
    s_cbranch_scc0 L_notq
    v_lshlrev_b32 v33, 3, v20
    ds_read_b64 v[96:97], v33 offset:31040
    ds_read_b64 v[98:99], v33 offset:31552
    ds_read_b64 v[100:101], v33 offset:32064
    ds_read_b64 v[102:103], v33 offset:32576
    v_lshlrev_b32 v6, 5, v22
    v_and_b32 v7, 1, v0
    v_lshl_add_u32 v6, v7, 4, v6
    v_bfe_u32 v7, v0, 1, 3
    v_add_lshl_u32 v6, v6, v7, 1
    v_mov_b32 v29, 1
    s_waitcnt lgkmcnt(0)
    v_add_f32 v96, v96, v98
    v_add_f32 v97, v97, v99
    v_add_f32 v100, v100, v102
    v_add_f32 v101, v101, v103
    v_add_f32 v96, v96, v100
    v_add_f32 v97, v97, v101
    v_cvt_pk_bf16_f32 v96, v96, v97
    ds_write_b16 v6, v96 offset:18432
    ds_write_b16_d16_hi v6, v96 offset:18448
    v_mov_b32 v97, s90
    ds_write_b32 v8, v97 offset:26928
    ds_write_b32 v8, v29 offset:27464
    ds_read_b32 v33, v8 offset:27488
    v_bfe_u32 v6, v0, 4, 2
    v_lshlrev_b32 v6, 7, v6
    v_and_b32 v7, 3, v0
    v_lshl_add_u32 v6, v7, 5, v6
    v_bfe_u32 v7, v0, 2, 2
    v_lshl_add_u32 v6, v7, 2, v6
    v_add_u32 v6, 18688, v6
    v_add_u32 v7, 16, v6
    ds_read2st64_b32 v[128:129], v6 offset0:0 offset1:2
    ds_read2st64_b32 v[130:131], v6 offset0:4 offset1:6
    ds_read2st64_b32 v[132:133], v6 offset0:8 offset1:10
    ds_read2st64_b32 v[134:135], v6 offset0:12 offset1:14
    ds_read2st64_b32 v[136:137], v6 offset0:16 offset1:18
    ds_read2st64_b32 v[138:139], v6 offset0:20 offset1:22
    ds_read2st64_b32 v[140:141], v6 offset0:24 offset1:26
    ds_read2st64_b32 v[142:143], v6 offset0:28 offset1:30
    s_waitcnt lgkmcnt(0)
    ds_read2st64_b32 v[144:145], v7 offset0:0 offset1:2
    ds_read2st64_b32 v[146:147], v7 offset0:4 offset1:6
    ds_read2st64_b32 v[148:149], v7 offset0:8 offset1:10
    ds_read2st64_b32 v[150:151], v7 offset0:12 offset1:14
    ds_read2st64_b32 v[152:153], v7 offset0:16 offset1:18
    ds_read2st64_b32 v[154:155], v7 offset0:20 offset1:22
    ds_read2st64_b32 v[156:157], v7 offset0:24 offset1:26
    ds_read2st64_b32 v[158:159], v7 offset0:28 offset1:30
    s_waitcnt lgkmcnt(0)
    v_add_f32 v128, v128, v136
    v_add_f32 v129, v129, v137
    v_add_f32 v130, v130, v138
    v_add_f32 v131, v131, v139
    v_add_f32 v132, v132, v140
    v_add_f32 v133, v133, v141
    v_add_f32 v134, v134, v142
    v_add_f32 v135, v135, v143
    v_add_f32 v128, v128, v132
    v_add_f32 v129, v129, v133
    v_add_f32 v130, v130, v134
    v_add_f32 v131, v131, v135
    v_add_f32 v128, v128, v130
    v_add_f32 v129, v129, v131
    v_add_f32 v144, v144, v152
    v_add_f32 v145, v145, v153
    v_add_f32 v146, v146, v154
    v_add_f32 v147, v147, v155
    v_add_f32 v148, v148, v156
    v_add_f32 v149, v149, v157
    v_add_f32 v150, v150, v158
    v_add_f32 v151, v151, v159
    v_add_f32 v144, v144, v148
    v_add_f32 v145, v145, v149
    v_add_f32 v146, v146, v150
    v_add_f32 v147, v147, v151
    v_add_f32 v144, v144, v146
    v_add_f32 v145, v145, v147
    v_mov_b32 v132, v128
    v_mov_b32 v133, s90
    v_mov_b32 v134, v144
    v_mov_b32 v135, s90
    v_mov_b32 v136, v129
    v_mov_b32 v137, s90
    v_mov_b32 v138, v145
    v_mov_b32 v139, s90
    s_lshl_b32 s8, s47, 3
    s_add_u32 s8, s8, s11
    s_lshl_b32 s8, s8, 11
    v_readfirstlane_b32 s10, v33
    s_nop 0
    s_cmp_eq_u32 s10, 0
    s_cbranch_scc1 L_fpl
    buffer_store_dwordx4 v[132:135], v30, s[76:79], s8 offen sc1
    buffer_store_dwordx4 v[136:139], v30, s[76:79], s8 offen offset:1024 sc1
    s_branch L_nofpub
L_fpl:
    buffer_store_dwordx4 v[132:135], v30, s[76:79], s8 offen
    buffer_store_dwordx4 v[136:139], v30, s[76:79], s8 offen offset:1024
L_nofpub:
    s_cmp_ge_u32 s2, 252
    s_cbranch_scc0 L_notq
    v_mov_b32 v128, 0
    v_mov_b32 v129, 0
    v_mov_b32 v130, 0
    v_mov_b32 v131, 0
    s_sub_u32 s9, s2, 252
    s_lshl_b32 s8, s9, 12
    s_add_u32 s8, s8, 524288
    s_mov_b32 exec_lo, 0xffffffff
    s_mov_b32 exec_hi, 0x00000000
    buffer_store_dwordx4 v[128:131], v30, s[76:79], s8 offen sc1
    s_add_u32 s8, s8, 16384
    buffer_store_dwordx4 v[128:131], v30, s[76:79], s8 offen sc1
    s_add_u32 s8, s8, 16384
    buffer_store_dwordx4 v[128:131], v30, s[76:79], s8 offen sc1
    s_add_u32 s8, s8, 16384
    buffer_store_dwordx4 v[128:131], v30, s[76:79], s8 offen sc1
    s_add_u32 s8, s8, 16384
    buffer_store_dwordx4 v[128:131], v30, s[76:79], s8 offen sc1
    s_add_u32 s8, s8, 16384
    buffer_store_dwordx4 v[128:131], v30, s[76:79], s8 offen sc1
    s_add_u32 s8, s8, 16384
    buffer_store_dwordx4 v[128:131], v30, s[76:79], s8 offen sc1
    s_add_u32 s8, s8, 16384
    buffer_store_dwordx4 v[128:131], v30, s[76:79], s8 offen sc1
    s_add_u32 s8, s8, 16384
    buffer_store_dwordx4 v[128:131], v30, s[76:79], s8 offen sc1
    s_add_u32 s8, s8, 16384
    buffer_store_dwordx4 v[128:131], v30, s[76:79], s8 offen sc1
    s_add_u32 s8, s8, 16384
    buffer_store_dwordx4 v[128:131], v30, s[76:79], s8 offen sc1
    s_add_u32 s8, s8, 16384
    v_mov_b32 v140, s90
    s_lshl_b32 s8, s9, 7
    s_add_u32 s8, s8, 704512
    s_waitcnt vmcnt(0)
    s_mov_b64 exec, 1
    buffer_store_dword v140, v8, s[76:79], s8 offen sc1
    s_mov_b64 exec, -1
L_notq:
    s_nop 1
    buffer_load_dwordx4 v[64:67], v24, s[64:67], s42 offen nt
    buffer_load_dwordx4 v[68:71], v24, s[64:67], s43 offen nt
    s_waitcnt vmcnt(1)
    buffer_load_dwordx4 v[72:75], v24, s[64:67], s44 offen nt
    s_add_u32 s46, s45, s40
    s_waitcnt vmcnt(1)
    buffer_load_dwordx4 v[76:79], v24, s[64:67], s46 offen nt
    s_add_u32 s46, s45, s41
    s_waitcnt vmcnt(1)
    buffer_load_dwordx4 v[80:83], v24, s[64:67], s46 offen nt
    s_add_u32 s46, s45, s42
    s_waitcnt vmcnt(1)
    buffer_load_dwordx4 v[84:87], v24, s[64:67], s46 offen nt
    s_add_u32 s46, s45, s43
    s_waitcnt vmcnt(1)
    buffer_load_dwordx4 v[88:91], v24, s[64:67], s46 offen nt
    s_add_u32 s46, s45, s44
    s_waitcnt vmcnt(1)
    buffer_load_dwordx4 v[92:95], v24, s[64:67], s46 offen nt
    s_waitcnt vmcnt(1)
    buffer_load_dwordx4 v[96:99], v23, s[52:55], s40 offen nt
    s_waitcnt vmcnt(1)
    buffer_load_dwordx4 v[100:103], v23, s[52:55], s41 offen nt
    s_waitcnt vmcnt(1)
    buffer_load_dwordx4 v[104:107], v23, s[52:55], s42 offen nt
    s_waitcnt vmcnt(1)
    buffer_load_dwordx4 v[108:111], v23, s[52:55], s43 offen nt
    s_waitcnt vmcnt(1)
    buffer_load_dwordx4 v[112:115], v23, s[52:55], s44 offen nt
    s_add_u32 s46, s40, 5120
    s_waitcnt vmcnt(1)
    buffer_load_dwordx4 v[176:179], v23, s[52:55], s46 offen nt
    s_add_u32 s46, s41, 5120
    s_waitcnt vmcnt(1)
    buffer_load_dwordx4 v[180:183], v23, s[52:55], s46 offen nt
    s_add_u32 s46, s42, 5120
    s_waitcnt vmcnt(1)
    buffer_load_dwordx4 v[184:187], v23, s[52:55], s46 offen nt
    s_add_u32 s46, s43, 5120
    s_waitcnt vmcnt(1)
    buffer_load_dwordx4 v[188:191], v23, s[52:55], s46 offen nt
    s_add_u32 s46, s44, 5120
    s_waitcnt vmcnt(1)
    buffer_load_dwordx4 v[192:195], v23, s[52:55], s46 offen nt
    s_add_u32 s46, s40, 10240
    s_waitcnt vmcnt(1)
    buffer_load_dwordx4 v[116:119], v23, s[52:55], s46 offen nt
    s_add_u32 s46, s41, 10240
    s_waitcnt vmcnt(1)
    buffer_load_dwordx4 v[120:123], v23, s[52:55], s46 offen nt
    s_add_u32 s46, s42, 10240
    s_waitcnt vmcnt(1)
    buffer_load_dwordx4 v[124:127], v23, s[52:55], s46 offen nt
    s_add_u32 s46, s43, 10240
    s_waitcnt vmcnt(1)
    buffer_load_dwordx4 v[128:131], v23, s[52:55], s46 offen nt
    s_add_u32 s46, s44, 10240
    s_waitcnt vmcnt(1)
    buffer_load_dwordx4 v[132:135], v23, s[52:55], s46 offen nt
    s_add_u32 s46, s40, 15360
    s_waitcnt vmcnt(1)
    buffer_load_dwordx4 v[196:199], v23, s[52:55], s46 offen nt
    s_add_u32 s46, s41, 15360
    s_waitcnt vmcnt(1)
    buffer_load_dwordx4 v[200:203], v23, s[52:55], s46 offen nt
    s_add_u32 s46, s42, 15360
    s_waitcnt vmcnt(1)
    buffer_load_dwordx4 v[204:207], v23, s[52:55], s46 offen nt
    s_add_u32 s46, s43, 15360
    s_waitcnt vmcnt(1)
    buffer_load_dwordx4 v[208:211], v23, s[52:55], s46 offen nt
    s_add_u32 s46, s44, 15360
    s_waitcnt vmcnt(1)
    buffer_load_dwordx4 v[212:215], v23, s[52:55], s46 offen nt
    s_add_u32 s46, s40, 20480
    s_waitcnt vmcnt(1)
    buffer_load_dwordx4 v[136:139], v23, s[52:55], s46 offen nt
    s_add_u32 s46, s41, 20480
    s_waitcnt vmcnt(1)
    buffer_load_dwordx4 v[140:143], v23, s[52:55], s46 offen nt
    s_add_u32 s46, s42, 20480
    s_waitcnt vmcnt(1)
    buffer_load_dwordx4 v[144:147], v23, s[52:55], s46 offen nt
    s_add_u32 s46, s43, 20480
    s_waitcnt vmcnt(1)
    buffer_load_dwordx4 v[148:151], v23, s[52:55], s46 offen nt
    s_add_u32 s46, s44, 20480
    s_waitcnt vmcnt(1)
    buffer_load_dwordx4 v[152:155], v23, s[52:55], s46 offen nt
    s_add_u32 s46, s40, 25600
    s_waitcnt vmcnt(1)
    buffer_load_dwordx4 v[216:219], v23, s[52:55], s46 offen nt
    s_add_u32 s46, s41, 25600
    s_waitcnt vmcnt(1)
    buffer_load_dwordx4 v[220:223], v23, s[52:55], s46 offen nt
    s_add_u32 s46, s42, 25600
    s_waitcnt vmcnt(1)
    buffer_load_dwordx4 v[224:227], v23, s[52:55], s46 offen nt
    s_add_u32 s46, s43, 25600
    s_waitcnt vmcnt(1)
    buffer_load_dwordx4 v[228:231], v23, s[52:55], s46 offen nt
    s_add_u32 s46, s44, 25600
    s_waitcnt vmcnt(1)
    buffer_load_dwordx4 v[232:235], v23, s[52:55], s46 offen nt
    s_add_u32 s46, s40, 30720
    s_waitcnt vmcnt(1)
    buffer_load_dwordx4 v[156:159], v23, s[52:55], s46 offen nt
    s_add_u32 s46, s41, 30720
    s_waitcnt vmcnt(1)
    buffer_load_dwordx4 v[160:163], v23, s[52:55], s46 offen nt
    s_add_u32 s46, s42, 30720
    s_waitcnt vmcnt(1)
    buffer_load_dwordx4 v[164:167], v23, s[52:55], s46 offen nt
    s_add_u32 s46, s43, 30720
    s_waitcnt vmcnt(1)
    buffer_load_dwordx4 v[168:171], v23, s[52:55], s46 offen nt
    s_add_u32 s46, s44, 30720
    s_waitcnt vmcnt(1)
    buffer_load_dwordx4 v[172:175], v23, s[52:55], s46 offen nt
    s_add_u32 s46, s40, 35840
    s_waitcnt vmcnt(1)
    buffer_load_dwordx4 v[236:239], v23, s[52:55], s46 offen nt
    s_add_u32 s46, s41, 35840
    s_waitcnt vmcnt(1)
    buffer_load_dwordx4 v[240:243], v23, s[52:55], s46 offen nt
    s_add_u32 s46, s42, 35840
    s_waitcnt vmcnt(1)
    buffer_load_dwordx4 v[244:247], v23, s[52:55], s46 offen nt
    s_add_u32 s46, s43, 35840
    s_waitcnt vmcnt(1)
    buffer_load_dwordx4 v[248:251], v23, s[52:55], s46 offen nt
    s_add_u32 s46, s44, 35840
    s_waitcnt vmcnt(1)
    buffer_load_dwordx4 v[252:255], v23, s[52:55], s46 offen nt
    v_bfe_u32 v29, v0, 3, 1
    v_lshlrev_b32 v29, 8, v29
    v_lshl_add_u32 v28, v28, 2, v29
    s_cmp_eq_u32 s15, 0
    s_cbranch_scc0 L_nosvc1
    s_mul_i32 s12, s6, 27
    s_and_b32 s9, s12, -2
    v_min_u32 v29, 13, v21
    v_lshl_add_u32 v29, v29, 1, s9
    v_lshlrev_b32 v30, 3, v29
    v_lshl_add_u32 v30, v22, 11, v30
    s_lshl_b32 s8, s5, 9
    s_lshl_b32 s13, s47, 14
    s_add_u32 s8, s8, s13
    s_add_u32 s13, s8, 8192
    s_lshl_b32 s14, s5, 7
    s_add_u32 s14, s14, 704512
    s_load_dword s10, s[38:39], s14
    s_mov_b32 s9, 0x40000
    v_mov_b32 v44, s90
    s_waitcnt lgkmcnt(0)
    s_cmp_eq_u32 s10, s90
    s_cselect_b32 s11, 1, 0
L_poll:
    buffer_load_dwordx4 v[36:39], v30, s[76:79], s8 offen sc1
    buffer_load_dwordx4 v[40:43], v30, s[76:79], s13 offen sc1
L_fchk:
    s_cmp_eq_u32 s11, 1
    s_cbranch_scc1 L_nofl
    buffer_load_dword v44, v8, s[76:79], s14 offen sc1
L_nofl:
    s_waitcnt vmcnt(0)
    v_xor_b32 v45, s90, v44
    v_xor_b32 v37, s90, v37
    v_xor_b32 v39, s90, v39
    v_xor_b32 v41, s90, v41
    v_xor_b32 v43, s90, v43
    v_or3_b32 v45, v45, v37, v39
    v_or3_b32 v45, v45, v41, v43
    v_cmp_ne_u32 vcc, 0, v45
    s_sub_u32 s9, s9, 1
    s_nop 3
    s_cbranch_vccz L_polldone
    s_cmp_eq_u32 s9, 0
    s_cbranch_scc1 L_polldone
    s_sleep 32
    s_branch L_poll
L_polldone:
    v_mov_b32 v37, v36
    v_mov_b32 v39, v38
    v_mov_b32 v41, v40
    v_mov_b32 v43, v42
    v_permlane32_swap_b32 v36, v37
    v_permlane32_swap_b32 v38, v39
    v_permlane32_swap_b32 v40, v41
    v_permlane32_swap_b32 v42, v43
    v_add_f32 v36, v36, v37
    v_add_f32 v38, v38, v39
    v_add_f32 v40, v40, v41
    v_add_f32 v42, v42, v43
    v_mov_b32 v37, v36
    v_mov_b32 v39, v38
    v_mov_b32 v41, v40
    v_mov_b32 v43, v42
    v_permlane16_swap_b32 v36, v37
    v_permlane16_swap_b32 v38, v39
    v_permlane16_swap_b32 v40, v41
    v_permlane16_swap_b32 v42, v43
    v_add_f32 v36, v36, v37
    v_add_f32 v38, v38, v39
    v_add_f32 v40, v40, v41
    v_add_f32 v42, v42, v43
    s_mov_b32 s10, 0xffff0000
    s_mov_b32 s11, 0xffff0000
    v_cndmask_b32 v36, v36, v38, s[10:11]
    v_cndmask_b32 v40, v40, v42, s[10:11]
    v_and_b32 v30, 1, v22
    v_add_u32 v29, v29, v30
    v_subrev_u32 v29, s12, v29
    v_cvt_pk_bf16_f32 v37, v36, v40
    v_lshlrev_b32 v36, 16, v37
    v_and_b32 v40, 0xffff0000, v37
    v_mul_f32 v38, 0xbfb8aa3b, v36
    v_exp_f32 v38, v38
    v_cmp_gt_u32 vcc, 27, v29
    v_add_f32 v38, 1.0, v38
    v_rcp_f32 v38, v38
    v_lshlrev_b32 v29, 2, v29
    v_mul_f32 v36, v36, v38
    v_cvt_pk_bf16_f32 v36, v36, v36
    v_and_b32 v36, 0xffff0000, v36
    v_mul_f32 v36, v36, v40
    v_cvt_pk_bf16_f32 v36, v36, v36
    v_mov_b32 v37, 1
    s_mov_b64 exec, vcc
    ds_write_b32 v29, v36 offset:26944
    ds_write_b32 v8, v37 offset:27472
    s_mov_b64 exec, -1
L_nosvc1:
    s_mov_b32 s9, 0x800000
L_sp151:
    ds_read_b32 v29, v8 offset:27472
    ds_read_b32 v30, v28 offset:26944
    ds_read_b32 v31, v28 offset:26960
    s_waitcnt lgkmcnt(0)
    v_readfirstlane_b32 s10, v29
    s_nop 0
    s_cmp_ge_u32 s10, 1
    s_cbranch_scc1 L_spd152
    s_sub_u32 s9, s9, 1
    s_cmp_eq_u32 s9, 0
    s_cbranch_scc1 L_spd152
    s_sleep 16
    s_branch L_sp151
L_spd152:
    v_and_b32 v12, v30, v2
    v_and_b32 v13, v30, v3
    v_and_b32 v14, v30, v4
    v_and_b32 v15, v30, v5
    v_and_b32 v16, v31, v2
    v_and_b32 v17, v31, v3
    v_and_b32 v18, v31, v4
    v_and_b32 v19, v31, v5
    v_mfma_f32_16x16x32_bf16 v[36:39], v[56:59], v[12:15], 0
    v_mfma_f32_16x16x32_bf16 v[40:43], v[60:63], v[12:15], 0
    v_mfma_f32_16x16x32_bf16 v[44:47], v[64:67], v[12:15], 0
    v_mfma_f32_16x16x32_bf16 v[48:51], v[68:71], v[12:15], 0
    v_mfma_f32_16x16x32_bf16 v[52:55], v[72:75], v[12:15], 0
    v_mfma_f32_16x16x32_bf16 v[36:39], v[76:79], v[16:19], v[36:39]
    v_mfma_f32_16x16x32_bf16 v[40:43], v[80:83], v[16:19], v[40:43]
    v_mfma_f32_16x16x32_bf16 v[44:47], v[84:87], v[16:19], v[44:47]
    v_mfma_f32_16x16x32_bf16 v[48:51], v[88:91], v[16:19], v[48:51]
    v_mfma_f32_16x16x32_bf16 v[52:55], v[92:95], v[16:19], v[52:55]
    s_cmp_eq_u32 s15, 0
    s_cbranch_scc0 L_nosvc2
    v_and_b32 v29, 3, v0
    v_lshlrev_b32 v28, 3, v29
    v_lshlrev_b32 v29, 2, v29
    s_mov_b32 s9, 0x800000
L_sp153:
    ds_read_b32 v32, v8 offset:27468
    ds_read_b64 v[30:31], v28 offset:26880
    ds_read_b32 v65, v8 offset:27488
    s_waitcnt lgkmcnt(0)
    v_readfirstlane_b32 s10, v32
    s_nop 0
    s_cmp_ge_u32 s10, 4
    s_cbranch_scc1 L_spd154
    s_sub_u32 s9, s9, 1
    s_cmp_eq_u32 s9, 0
    s_cbranch_scc1 L_spd154
    s_sleep 16
    s_branch L_sp153
L_spd154:
    v_max_f32_dpp v34, v30, v30 quad_perm:[1,0,3,2] row_mask:0xf bank_mask:0xf
    s_nop 1
    v_max_f32_dpp v34, v34, v34 quad_perm:[2,3,0,1] row_mask:0xf bank_mask:0xf
    v_sub_f32 v33, v30, v34
    v_mul_f32 v33, s91, v33
    v_exp_f32 v33, v33
    s_nop 0
    v_mul_f32 v35, v33, v31
    s_nop 1
    v_add_f32_dpp v35, v35, v35 quad_perm:[1,0,3,2] row_mask:0xf bank_mask:0xf
    s_nop 1
    v_add_f32_dpp v35, v35, v35 quad_perm:[2,3,0,1] row_mask:0xf bank_mask:0xf
    v_mov_b32 v56, v34
    v_mov_b32 v57, s90
    v_mov_b32 v58, v35
    v_mov_b32 v59, s90
    s_lshl_b32 s9, s2, 7
    s_add_u32 s8, s9, 720896
    v_lshlrev_b32 v64, 4, v20
    v_readfirstlane_b32 s10, v65
    s_mov_b64 exec, 15
    s_cmp_eq_u32 s10, 0
    s_cbranch_scc1 L_mbl
    buffer_store_dwordx4 v[56:59], v64, s[76:79], s8 offen sc1
    s_branch L_mbs
L_mbl:
    buffer_store_dwordx4 v[56:59], v64, s[76:79], s8 offen
L_mbs:
    s_mov_b64 exec, -1
    s_xor_b32 s8, s8, 4096
    s_mov_b32 s9, 0x40000
    s_sleep 127
    s_load_dwordx4 s[84:87], s[38:39], s8
    s_waitcnt lgkmcnt(0)
    v_mov_b32 v60, s84
    v_mov_b32 v62, s86
    s_cmp_eq_u32 s85, s90
    s_cbranch_scc0 L_mb
    s_cmp_eq_u32 s87, s90
    s_cbranch_scc1 L_mbdone
L_mb:
    s_sleep 64
    buffer_load_dwordx4 v[60:63], v8, s[76:79], s8 offen sc1
    s_waitcnt vmcnt(0)
    v_readfirstlane_b32 s10, v61
    v_readfirstlane_b32 s14, v63
    s_sub_u32 s9, s9, 1
    s_cmp_eq_u32 s9, 0
    s_cbranch_scc1 L_mbdone
    s_cmp_eq_u32 s10, s90
    s_cbranch_scc0 L_mb
    s_cmp_eq_u32 s14, s90
    s_cbranch_scc0 L_mb
L_mbdone:
    v_max_f32 v26, v34, v60
    v_sub_f32 v27, v34, v26
    v_sub_f32 v28, v60, v26
    v_mul_f32 v27, s91, v27
    v_mul_f32 v28, s91, v28
    v_exp_f32 v27, v27
    v_exp_f32 v28, v28
    v_mul_f32 v26, v35, v27
    v_fmac_f32 v26, v62, v28
    v_rcp_f32 v26, v26
    v_mul_f32 v27, v27, v33
    v_mul_f32 v26, v26, v27
    v_mov_b32 v27, 1
    ds_write_b32 v29, v26 offset:26912
    ds_write_b32 v8, v27 offset:27476
L_nosvc2:
    s_add_u32 s9, s3, 0
    s_mul_i32 s10, s9, 60
    v_bfe_u32 v26, v0, 4, 2
    v_mul_u32_u24 v27, 15, v26
    v_and_b32 v89, 15, v0
    v_add3_u32 v27, v27, v89, s10
    v_cmp_gt_u32 vcc, 15, v89
    v_mov_b32 v90, 0x3ff
    s_nop 0
    v_cndmask_b32 v27, v90, v27, vcc
    s_lshl_b32 s9, s9, 2
    s_add_u32 s9, s9, s5
    s_lshl_b32 s9, s9, 12
    s_add_u32 s9, s9, 524288
    v_lshlrev_b32 v89, 2, v89
    v_lshl_add_u32 v89, v26, 7, v89
    v_add_u32 v89, s9, v89
    s_mul_i32 s9, s5, 1280
    v_lshl_add_u32 v90, v27, 1, s9
    v_cmp_gt_u32 vcc, 640, v27
    v_mov_b32 v26, 0x7fff0000
    s_nop 0
    v_cndmask_b32 v90, v26, v90, vcc
    v_cndmask_b32 v27, 0, v27, vcc
    s_mov_b64 s[92:93], vcc
    v_lshrrev_b32 v88, 5, v27
    v_lshlrev_b32 v88, 8, v88
    v_and_b32 v26, 7, v27
    v_lshl_add_u32 v88, v26, 4, v88
    v_bfe_u32 v26, v27, 3, 2
    v_lshl_add_u32 v88, v26, 2, v88
    v_add_u32 v88, 31040, v88
    buffer_load_ushort v91, v90, s[56:59], 0 offen
    s_lshl_b32 s9, s15, 7
    v_lshl_add_u32 v11, v22, 4, s9
    v_cmp_lt_u32 vcc, 7, v21
    v_mov_b32 v29, 0xffff0000
    s_nop 0
    v_cndmask_b32 v31, 0, v29, vcc
    v_mov_b32 v29, 0x03020302
    v_mov_b32 v30, 0x0c0c0c0c
    v_bfi_b32 v32, v2, v29, v30
    v_bfi_b32 v33, v3, v29, v30
    v_bfi_b32 v34, v4, v29, v30
    v_bfi_b32 v35, v5, v29, v30
    s_mul_i32 s9, s15, 5120
    v_lshl_add_u32 v28, v20, 4, s9
    s_lshl_b32 s10, s40, 2
    v_add_u32 v92, s10, v28
    s_lshl_b32 s10, s41, 2
    v_add_u32 v93, s10, v28
    s_lshl_b32 s10, s42, 2
    v_add_u32 v94, s10, v28
    s_lshl_b32 s10, s43, 2
    v_add_u32 v95, s10, v28
    s_lshl_b32 s10, s44, 2
    v_add_u32 v28, s10, v28
    s_waitcnt vmcnt(0) lgkmcnt(0)
    s_barrier
    ds_read_b128 v[12:15], v11 offset:28992
    ds_read_b128 v[16:19], v11 offset:29504
    ds_read_b128 v[20:23], v11 offset:30016
    ds_read_b128 v[24:27], v11 offset:30528
    ds_read_b128 v[72:75], v11 offset:29056
    ds_read_b128 v[76:79], v11 offset:29568
    ds_read_b128 v[80:83], v11 offset:30080
    ds_read_b128 v[84:87], v11 offset:30592
    s_waitcnt lgkmcnt(4)
    v_pk_add_f32 v[12:13], v[12:13], v[16:17]
    v_pk_add_f32 v[20:21], v[20:21], v[24:25]
    v_pk_add_f32 v[12:13], v[12:13], v[20:21]
    v_and_b32 v29, v12, v31
    v_sub_f32 v12, v12, v29
    v_perm_b32 v56, v12, v12, v32
    v_perm_b32 v57, v12, v12, v33
    v_perm_b32 v58, v12, v12, v34
    v_perm_b32 v59, v12, v12, v35
    s_nop 1
    v_mfma_f32_16x16x32_bf16 v[36:39], v[96:99], v[56:59], v[36:39]
    v_and_b32 v30, v13, v31
    v_sub_f32 v13, v13, v30
    v_mfma_f32_16x16x32_bf16 v[40:43], v[100:103], v[56:59], v[40:43]
    v_perm_b32 v60, v13, v13, v32
    v_perm_b32 v61, v13, v13, v33
    v_mfma_f32_16x16x32_bf16 v[44:47], v[104:107], v[56:59], v[44:47]
    v_perm_b32 v62, v13, v13, v34
    v_perm_b32 v63, v13, v13, v35
    v_mfma_f32_16x16x32_bf16 v[48:51], v[108:111], v[56:59], v[48:51]
    v_pk_add_f32 v[14:15], v[14:15], v[18:19]
    v_pk_add_f32 v[22:23], v[22:23], v[26:27]
    v_mfma_f32_16x16x32_bf16 v[52:55], v[112:115], v[56:59], v[52:55]
    v_pk_add_f32 v[14:15], v[14:15], v[22:23]
    v_and_b32 v29, v14, v31
    v_mfma_f32_16x16x32_bf16 v[36:39], v[116:119], v[60:63], v[36:39]
    v_sub_f32 v14, v14, v29
    v_perm_b32 v64, v14, v14, v32
    v_mfma_f32_16x16x32_bf16 v[40:43], v[120:123], v[60:63], v[40:43]
    v_perm_b32 v65, v14, v14, v33
    v_perm_b32 v66, v14, v14, v34
    v_mfma_f32_16x16x32_bf16 v[44:47], v[124:127], v[60:63], v[44:47]
    v_perm_b32 v67, v14, v14, v35
    s_waitcnt lgkmcnt(0)
    v_mfma_f32_16x16x32_bf16 v[48:51], v[128:131], v[60:63], v[48:51]
    v_pk_add_f32 v[72:73], v[72:73], v[76:77]
    v_pk_add_f32 v[80:81], v[80:81], v[84:85]
    v_mfma_f32_16x16x32_bf16 v[52:55], v[132:135], v[60:63], v[52:55]
    v_pk_add_f32 v[16:17], v[72:73], v[80:81]
    v_pk_add_f32 v[74:75], v[74:75], v[78:79]
    v_mfma_f32_16x16x32_bf16 v[36:39], v[136:139], v[64:67], v[36:39]
    v_pk_add_f32 v[82:83], v[82:83], v[86:87]
    v_pk_add_f32 v[18:19], v[74:75], v[82:83]
    v_mfma_f32_16x16x32_bf16 v[40:43], v[140:143], v[64:67], v[40:43]
    v_and_b32 v30, v15, v31
    v_sub_f32 v15, v15, v30
    v_mfma_f32_16x16x32_bf16 v[44:47], v[144:147], v[64:67], v[44:47]
    v_perm_b32 v68, v15, v15, v32
    v_perm_b32 v69, v15, v15, v33
    v_mfma_f32_16x16x32_bf16 v[48:51], v[148:151], v[64:67], v[48:51]
    v_perm_b32 v70, v15, v15, v34
    v_perm_b32 v71, v15, v15, v35
    v_mfma_f32_16x16x32_bf16 v[52:55], v[152:155], v[64:67], v[52:55]
    v_and_b32 v29, v16, v31
    v_sub_f32 v16, v16, v29
    v_mfma_f32_16x16x32_bf16 v[36:39], v[156:159], v[68:71], v[36:39]
    v_perm_b32 v72, v16, v16, v32
    v_perm_b32 v73, v16, v16, v33
    v_mfma_f32_16x16x32_bf16 v[40:43], v[160:163], v[68:71], v[40:43]
    v_perm_b32 v74, v16, v16, v34
    v_perm_b32 v75, v16, v16, v35
    v_mfma_f32_16x16x32_bf16 v[44:47], v[164:167], v[68:71], v[44:47]
    v_and_b32 v30, v17, v31
    v_sub_f32 v17, v17, v30
    v_mfma_f32_16x16x32_bf16 v[48:51], v[168:171], v[68:71], v[48:51]
    v_perm_b32 v76, v17, v17, v32
    v_perm_b32 v77, v17, v17, v33
    v_mfma_f32_16x16x32_bf16 v[52:55], v[172:175], v[68:71], v[52:55]
    v_perm_b32 v78, v17, v17, v34
    v_perm_b32 v79, v17, v17, v35
    v_mfma_f32_16x16x32_bf16 v[36:39], v[176:179], v[72:75], v[36:39]
    v_and_b32 v29, v18, v31
    v_sub_f32 v18, v18, v29
    v_mfma_f32_16x16x32_bf16 v[40:43], v[180:183], v[72:75], v[40:43]
    v_perm_b32 v80, v18, v18, v32
    v_perm_b32 v81, v18, v18, v33
    v_mfma_f32_16x16x32_bf16 v[44:47], v[184:187], v[72:75], v[44:47]
    v_perm_b32 v82, v18, v18, v34
    v_perm_b32 v83, v18, v18, v35
    v_mfma_f32_16x16x32_bf16 v[48:51], v[188:191], v[72:75], v[48:51]
    v_and_b32 v30, v19, v31
    v_sub_f32 v19, v19, v30
    v_mfma_f32_16x16x32_bf16 v[52:55], v[192:195], v[72:75], v[52:55]
    v_perm_b32 v84, v19, v19, v32
    v_perm_b32 v85, v19, v19, v33
    v_mfma_f32_16x16x32_bf16 v[36:39], v[196:199], v[76:79], v[36:39]
    v_perm_b32 v86, v19, v19, v34
    v_perm_b32 v87, v19, v19, v35
    v_mfma_f32_16x16x32_bf16 v[36:39], v[216:219], v[80:83], v[36:39]
    s_nop 0
    v_mfma_f32_16x16x32_bf16 v[36:39], v[236:239], v[84:87], v[36:39]
    v_mfma_f32_16x16x32_bf16 v[40:43], v[200:203], v[76:79], v[40:43]
    v_mfma_f32_16x16x32_bf16 v[40:43], v[220:223], v[80:83], v[40:43]
    v_mfma_f32_16x16x32_bf16 v[40:43], v[240:243], v[84:87], v[40:43]
    v_mfma_f32_16x16x32_bf16 v[44:47], v[204:207], v[76:79], v[44:47]
    v_mfma_f32_16x16x32_bf16 v[44:47], v[224:227], v[80:83], v[44:47]
    v_mfma_f32_16x16x32_bf16 v[44:47], v[244:247], v[84:87], v[44:47]
    v_mfma_f32_16x16x32_bf16 v[48:51], v[208:211], v[76:79], v[48:51]
    v_mfma_f32_16x16x32_bf16 v[48:51], v[228:231], v[80:83], v[48:51]
    ds_write_b128 v92, v[36:39] offset:31040
    v_mfma_f32_16x16x32_bf16 v[48:51], v[248:251], v[84:87], v[48:51]
    v_mfma_f32_16x16x32_bf16 v[52:55], v[212:215], v[76:79], v[52:55]
    v_mfma_f32_16x16x32_bf16 v[52:55], v[232:235], v[80:83], v[52:55]
    ds_write_b128 v93, v[40:43] offset:31040
    v_mfma_f32_16x16x32_bf16 v[52:55], v[252:255], v[84:87], v[52:55]
    ds_write_b128 v94, v[44:47] offset:31040
    s_nop 2
    ds_write_b128 v95, v[48:51] offset:31040
    s_nop 2
    ds_write_b128 v28, v[52:55] offset:31040
    s_waitcnt lgkmcnt(0)
    s_barrier
    v_add_u32 v104, 128, v88
    ds_read2st64_b32 v[96:97], v88 offset0:0 offset1:20
    ds_read2st64_b32 v[98:99], v88 offset0:40 offset1:60
    ds_read2st64_b32 v[100:101], v104 offset0:0 offset1:20
    ds_read2st64_b32 v[102:103], v104 offset0:40 offset1:60
    s_waitcnt lgkmcnt(0)
    v_add_f32 v96, v96, v100
    v_add_f32 v97, v97, v101
    v_add_f32 v98, v98, v102
    v_add_f32 v99, v99, v103
    v_add_f32 v96, v96, v97
    v_add_f32 v98, v98, v99
    v_add_f32 v96, v96, v98
    v_cndmask_b32 v96, 1.0, v96, s[92:93]
    v_mov_b32 v97, v96
    buffer_atomic_add_f32 v97, v89, s[76:79], 0 offen sc0
    v_lshlrev_b32 v91, 16, v91
    v_add_f32 v96, v96, v91
    s_waitcnt vmcnt(0)
    v_mov_b32_dpp v98, v97 row_newbcast:15 row_mask:0xf bank_mask:0xf
    v_add_f32 v96, v96, v97
    v_cmp_eq_f32 vcc, 0x427c0000, v98
    v_cvt_pk_bf16_f32 v96, v96, v96
    s_and_saveexec_b64 s[12:13], vcc
    s_cbranch_execz L_nf155
    buffer_store_short v96, v90, s[68:71], 0 offen
    s_or_b32 s9, s5, s3
    s_cmp_eq_u32 s9, 0
    s_cbranch_scc0 L_nf155
    s_and_b64 exec, exec, 1
    s_cbranch_execz L_nf155
    v_mov_b32 v99, s90
    s_mov_b32 s8, 1835008
    buffer_store_dword v99, v8, s[76:79], s8 offen
L_nf155:
    s_mov_b64 exec, -1
L_end:
    s_endpgm
L_codeend:
.section .rodata,"a"
.p2align 6
.amdhsa_kernel parallel_sum__mha_block_cached__swiglu_ffn__decode_kernel
  .amdhsa_next_free_vgpr 256
  .amdhsa_next_free_sgpr 102
  .amdhsa_accum_offset 256
  .amdhsa_group_segment_fixed_size 0
  .amdhsa_kernarg_size 96
  .amdhsa_user_sgpr_count 2
  .amdhsa_user_sgpr_kernarg_segment_ptr 1
  .amdhsa_system_sgpr_workgroup_id_x 1
  .amdhsa_float_denorm_mode_32 3
.end_amdhsa_kernel
```
